```python
import torch

def _softmax(x, axis=-1):
    return torch.softmax(x, dim=axis)
def _gelu(x):
    return torch.nn.functional.gelu(x, approximate="tanh")
def _silu(x):
    return torch.nn.functional.silu(x)
def _sigmoid(x):
    return torch.sigmoid(x)
def _layernorm(x, axis=-1, eps=1e-5):
    m = x.mean(dim=axis, keepdim=True)
    v = x.var(dim=axis, keepdim=True, unbiased=False)
    return (x - m) / torch.sqrt(v + eps)
def _scatter_add(tgt, idx, src, axis=0):
    return tgt.clone().index_add_(axis, idx, src)
def _segment_sum(src, seg, n):
    out = torch.zeros((n,) + src.shape[1:], dtype=src.dtype)
    return out.index_add_(0, seg, src)
def _pad(x, pw):
    flat = tuple(v for pair in reversed(pw) for v in pair)
    return torch.nn.functional.pad(x, flat)

kernel_name = 'concat_heads__mha_block_cached__mha_block_cached__decode'

def setup_inputs():

    _w = (lambda a: (lambda t: t.to(torch.bfloat16) if t.is_floating_point() else t)(torch.as_tensor(a)))
    def _A_setup():
        B, Sq, D = 8, 1, 1024
        H, Sk, Dh = 32, 4096, 128
        return {
            "x": _w((lambda *s: torch.randn(*s, dtype=torch.bfloat16) * 0.8)(B, Sq, D)),
            "k_cache": _w((lambda *s: torch.randn(*s, dtype=torch.bfloat16) * 0.8)(B, H, Sk, Dh)),
            "v_cache": _w((lambda *s: torch.randn(*s, dtype=torch.bfloat16) * 0.05)(B, H, Sk, Dh)),
            "wq": _w((lambda *s: torch.randn(*s, dtype=torch.bfloat16) * 0.8)(D, H * Dh) * (D ** -0.5)),
            "wo": _w((lambda *s: torch.randn(*s, dtype=torch.bfloat16) * 0.05)(H * Dh, D) * ((H * Dh) ** -0.5)),
        }
    _A_in = _A_setup()

    def _B_setup():
        B, Sq, D = 8, 1, 1024
        H, Sk, Dh = 32, 4096, 128
        return {
            "x": _w((lambda *s: torch.randn(*s, dtype=torch.bfloat16) * 0.8)(B, Sq, D)),
            "k_cache": _w((lambda *s: torch.randn(*s, dtype=torch.bfloat16) * 0.8)(B, H, Sk, Dh)),
            "v_cache": _w((lambda *s: torch.randn(*s, dtype=torch.bfloat16) * 0.05)(B, H, Sk, Dh)),
            "wq": _w((lambda *s: torch.randn(*s, dtype=torch.bfloat16) * 0.8)(D, H * Dh) * (D ** -0.5)),
            "wo": _w((lambda *s: torch.randn(*s, dtype=torch.bfloat16) * 0.05)(H * Dh, D) * ((H * Dh) ** -0.5)),
        }
    _B_in = _B_setup()

    return {
        "A_x": _A_in["x"],
        "A_k_cache": _A_in["k_cache"],
        "A_v_cache": _A_in["v_cache"],
        "A_wq": _A_in["wq"],
        "A_wo": _A_in["wo"],
        "B_x": _B_in["x"],
        "B_k_cache": _B_in["k_cache"],
        "B_v_cache": _B_in["v_cache"],
        "B_wq": _B_in["wq"],
        "B_wo": _B_in["wo"],
    }

def reference(A_x, A_k_cache, A_v_cache, A_wq, A_wo, B_x, B_k_cache, B_v_cache, B_wq, B_wo):
    def _A_ref(x, k_cache, v_cache, wq, wo):
        B, Sq, D = x.shape
        H, Dh = 32, 128
        q = (lambda x, *d: x.permute(*d))((x @ wq).reshape(B, Sq, H, Dh), 0, 2, 1, 3)
        scores = torch.einsum("bhqd,bhkd->bhqk", q, k_cache) * (Dh ** -0.5)
        p = _softmax(scores, axis=-1)
        o = torch.einsum("bhqk,bhkd->bhqd", p, v_cache)
        return (lambda x, *d: x.permute(*d))(o, 0, 2, 1, 3).reshape(B, Sq, H * Dh) @ wo

    def _B_ref(x, k_cache, v_cache, wq, wo):
        B, Sq, D = x.shape
        H, Dh = 32, 128
        q = (lambda x, *d: x.permute(*d))((x @ wq).reshape(B, Sq, H, Dh), 0, 2, 1, 3)
        scores = torch.einsum("bhqd,bhkd->bhqk", q, k_cache) * (Dh ** -0.5)
        p = _softmax(scores, axis=-1)
        o = torch.einsum("bhqk,bhkd->bhqd", p, v_cache)
        return (lambda x, *d: x.permute(*d))(o, 0, 2, 1, 3).reshape(B, Sq, H * Dh) @ wo

    a = _A_ref(A_x, A_k_cache, A_v_cache, A_wq, A_wo)
    b = _B_ref(B_x, B_k_cache, B_v_cache, B_wq, B_wo)
    return torch.concatenate([a, b], axis=-1)
```

```asm
; @launch grid=(256,1,1) block=(320,1,1) lds=83200
.amdgcn_target "amdgcn-amd-amdhsa--gfx950"
.text
.globl concat_heads__mha_block_cached__mha_block_cached__decode_kernel
.p2align 8
.type concat_heads__mha_block_cached__mha_block_cached__decode_kernel,@function
concat_heads__mha_block_cached__mha_block_cached__decode_kernel:
    s_cmp_ge_u32 s2, 256
    s_cbranch_scc1 L_exit
    s_load_dwordx16 s[4:19], s[0:1], 0
    s_load_dwordx8 s[20:27], s[0:1], 64
    s_load_dwordx2 s[28:29], s[0:1], 96
    v_lshrrev_b32 v2, 6, v0
    v_and_b32 v1, 63, v0
    v_readfirstlane_b32 s3, v2
    s_lshr_b32 s77, s2, 6
    s_lshl_b32 s77, s77, 3
    s_and_b32 s81, s2, 7
    s_add_u32 s77, s77, s81
    s_bfe_u32 s78, s2, 0x30003
    s_mov_b32 s97, 0x500000
    v_and_b32 v2, 15, v1
    v_lshrrev_b32 v3, 4, v1
    v_lshlrev_b32 v7, 4, v1
    s_cmp_eq_u32 s3, 4
    s_waitcnt lgkmcnt(0)
    s_load_dword s76, s[28:29], s97
    s_mov_b32 s72, s28
    s_mov_b32 s73, s29
    s_mov_b32 s74, 0x600000
    s_mov_b32 s75, 0x20000
    s_cbranch_scc1 L_comm
    s_mov_b32 s40, s10
    s_mov_b32 s41, s11
    s_mov_b32 s42, 0x800000
    s_mov_b32 s43, 0x20000
    s_mov_b32 s32, s4
    s_mov_b32 s33, s5
    s_mov_b32 s34, 0x4000
    s_mov_b32 s35, 0x20000
    v_lshlrev_b32 v39, 1, v3
    v_xor_b32 v39, v39, v2
    v_lshlrev_b32 v39, 4, v39
    v_lshl_add_u32 v39, v3, 13, v39
    v_xor_b32 v109, 128, v39
    s_lshl_b32 s81, s78, 20
    s_lshl_b32 s82, s77, 8
    s_add_u32 s81, s81, s82
    s_lshl_b32 s82, s3, 18
    s_add_u32 s96, s81, s82
    s_lshl_b32 s95, s3, 13
    v_and_b32 v12, 7, v1
    v_lshlrev_b32 v12, 11, v12
    v_lshl_add_u32 v12, v3, 4, v12
    s_lshl_b32 s82, s78, 8
    s_mov_b32 s36, s14
    s_mov_b32 s37, s15
    s_mov_b32 s38, 0x4000
    s_mov_b32 s39, 0x20000
    buffer_load_dwordx4 v[76:79], v12, s[32:35], s82 offen offset:0
    buffer_load_dwordx4 v[80:83], v12, s[32:35], s82 offen offset:64
    buffer_load_dwordx4 v[84:87], v12, s[32:35], s82 offen offset:128
    buffer_load_dwordx4 v[88:91], v12, s[32:35], s82 offen offset:192
    buffer_load_dwordx4 v[92:95], v12, s[36:39], s82 offen offset:0
    buffer_load_dwordx4 v[96:99], v12, s[36:39], s82 offen offset:64
    buffer_load_dwordx4 v[100:103], v12, s[36:39], s82 offen offset:128
    buffer_load_dwordx4 v[104:107], v12, s[36:39], s82 offen offset:192
    s_add_u32 m0, s95, 17664
    s_add_u32 s81, s96, 0
    buffer_load_dwordx4 v39, s[40:43], s81 offen nt lds
    s_add_u32 m0, s95, 18688
    s_add_u32 s81, s96, 32768
    buffer_load_dwordx4 v39, s[40:43], s81 offen nt lds
    s_add_u32 m0, s95, 19712
    s_add_u32 s81, s96, 65536
    buffer_load_dwordx4 v109, s[40:43], s81 offen nt lds
    s_add_u32 m0, s95, 20736
    s_add_u32 s81, s96, 98304
    buffer_load_dwordx4 v109, s[40:43], s81 offen nt lds
    s_add_u32 m0, s95, 21760
    s_add_u32 s81, s96, 131072
    buffer_load_dwordx4 v39, s[40:43], s81 offen nt lds
    s_add_u32 m0, s95, 22784
    s_add_u32 s81, s96, 163840
    buffer_load_dwordx4 v39, s[40:43], s81 offen nt lds
    s_add_u32 m0, s95, 23808
    s_add_u32 s81, s96, 196608
    buffer_load_dwordx4 v109, s[40:43], s81 offen nt lds
    s_add_u32 m0, s95, 24832
    s_add_u32 s81, s96, 229376
    buffer_load_dwordx4 v109, s[40:43], s81 offen nt lds
    s_mov_b32 s44, s20
    s_mov_b32 s45, s21
    s_mov_b32 s46, 0x800000
    s_mov_b32 s47, 0x20000
    s_add_u32 m0, s95, 50432
    s_add_u32 s81, s96, 0
    buffer_load_dwordx4 v39, s[44:47], s81 offen nt lds
    s_add_u32 m0, s95, 51456
    s_add_u32 s81, s96, 32768
    buffer_load_dwordx4 v39, s[44:47], s81 offen nt lds
    s_add_u32 m0, s95, 52480
    s_add_u32 s81, s96, 65536
    buffer_load_dwordx4 v109, s[44:47], s81 offen nt lds
    s_add_u32 m0, s95, 53504
    s_add_u32 s81, s96, 98304
    buffer_load_dwordx4 v109, s[44:47], s81 offen nt lds
    s_add_u32 m0, s95, 54528
    s_add_u32 s81, s96, 131072
    buffer_load_dwordx4 v39, s[44:47], s81 offen nt lds
    s_add_u32 m0, s95, 55552
    s_add_u32 s81, s96, 163840
    buffer_load_dwordx4 v39, s[44:47], s81 offen nt lds
    s_add_u32 m0, s95, 56576
    s_add_u32 s81, s96, 196608
    buffer_load_dwordx4 v109, s[44:47], s81 offen nt lds
    s_add_u32 m0, s95, 57600
    s_add_u32 s81, s96, 229376
    buffer_load_dwordx4 v109, s[44:47], s81 offen nt lds
    s_mov_b32 s48, s6
    s_mov_b32 s49, s7
    s_mov_b32 s50, 0x10000000
    s_mov_b32 s51, 0x20000
    s_lshl_b32 s93, s78, 5
    s_add_u32 s93, s93, s77
    s_lshl_b32 s93, s93, 20
    s_mul_i32 s81, s3, 8192
    s_add_u32 s93, s93, s81
    s_mov_b32 s79, s93
    buffer_load_dwordx4 v[128:131], v7, s[48:51], s79 offen offset:0 nt
    buffer_load_dwordx4 v[132:135], v7, s[48:51], s79 offen offset:1024 nt
    buffer_load_dwordx4 v[136:139], v7, s[48:51], s79 offen offset:2048 nt
    buffer_load_dwordx4 v[140:143], v7, s[48:51], s79 offen offset:3072 nt
    s_add_u32 s79, s79, 4096
    buffer_load_dwordx4 v[144:147], v7, s[48:51], s79 offen offset:0 nt
    buffer_load_dwordx4 v[148:151], v7, s[48:51], s79 offen offset:1024 nt
    buffer_load_dwordx4 v[152:155], v7, s[48:51], s79 offen offset:2048 nt
    buffer_load_dwordx4 v[156:159], v7, s[48:51], s79 offen offset:3072 nt
    s_add_u32 s79, s79, 28672
    s_mov_b32 s52, s8
    s_mov_b32 s53, s9
    s_mov_b32 s54, 0x10000000
    s_mov_b32 s55, 0x20000
    s_mov_b32 s56, s16
    s_mov_b32 s57, s17
    s_mov_b32 s58, 0x10000000
    s_mov_b32 s59, 0x20000
    s_mov_b32 s60, s18
    s_mov_b32 s61, s19
    s_mov_b32 s62, 0x10000000
    s_mov_b32 s63, 0x20000
    v_lshrrev_b32 v37, 2, v2
    v_and_b32 v38, 1, v3
    v_lshl_add_u32 v38, v38, 2, v37
    s_lshl_b32 s81, s3, 1
    v_xor_b32 v38, s81, v38
    v_lshlrev_b32 v38, 5, v38
    v_lshl_add_u32 v38, v3, 11, v38
    v_lshl_add_u32 v38, v37, 8, v38
    v_and_b32 v5, 3, v1
    v_lshl_add_u32 v38, v5, 3, v38
    v_xor_b32 v108, 32, v38
    v_add_u32 v38, 17664, v38
    v_add_u32 v108, 17664, v108
    s_mov_b32 s83, 0x3e0293ee
    s_mov_b32 s86, 0xcccccccc
    s_mov_b32 s87, 0xcccccccc
    s_mov_b32 s88, 0xaaaaaaaa
    s_mov_b32 s89, 0xaaaaaaaa
    s_mov_b32 s90, 0xff00ff00
    s_mov_b32 s91, 0xff00ff00
    v_mov_b32 v36, 0xffff
    v_mov_b32 v37, 0xffff0000
    v_cndmask_b32 v36, v36, v37, s[88:89]
    v_bfe_u32 v37, v1, 1, 2
    v_cmp_eq_u32 vcc, 0, v37
    s_nop 1
    v_cndmask_b32 v8, 0, v36, vcc
    v_cmp_eq_u32 vcc, 1, v37
    s_nop 1
    v_cndmask_b32 v9, 0, v36, vcc
    v_cmp_eq_u32 vcc, 2, v37
    s_nop 1
    v_cndmask_b32 v10, 0, v36, vcc
    v_cmp_eq_u32 vcc, 3, v37
    s_nop 1
    v_cndmask_b32 v11, 0, v36, vcc
    v_and_b32 v37, 7, v1
    v_mul_u32_u24 v110, 1040, v37
    v_bfe_u32 v37, v1, 3, 1
    v_lshl_add_u32 v110, v37, 6, v110
    v_lshl_add_u32 v110, v3, 4, v110
    s_lshl_b32 s81, s3, 7
    v_add_u32 v110, s81, v110
    v_mov_b32 v37, 0xff
    v_mov_b32 v111, 0
    v_mov_b32 v120, 1
    s_mov_b32 s85, 0
    s_mov_b32 s64, -4
    s_cmp_lg_u32 s3, 0
    s_cbranch_scc1 L_x0a
    buffer_load_dwordx4 v[160:163], v7, s[48:51], s79 offen offset:0 nt
    buffer_load_dwordx4 v[164:167], v7, s[48:51], s79 offen offset:1024 nt
    buffer_load_dwordx4 v[168:171], v7, s[48:51], s79 offen offset:2048 nt
    buffer_load_dwordx4 v[172:175], v7, s[48:51], s79 offen offset:3072 nt
    s_add_u32 s79, s79, 4096
    s_waitcnt vmcnt(12)
    s_branch L_x0b
L_x0a:
    s_waitcnt vmcnt(8)
L_x0b:
    s_barrier
    ds_read_b64_tr_b16 v[40:41], v38 offset:0
    ds_read_b64_tr_b16 v[42:43], v38 offset:1024
    ds_read_b64_tr_b16 v[44:45], v38 offset:8192
    ds_read_b64_tr_b16 v[46:47], v38 offset:9216
    ds_read_b64_tr_b16 v[48:49], v38 offset:16384
    ds_read_b64_tr_b16 v[50:51], v38 offset:17408
    ds_read_b64_tr_b16 v[52:53], v38 offset:24576
    ds_read_b64_tr_b16 v[54:55], v38 offset:25600
    ds_read_b64_tr_b16 v[56:57], v108 offset:0
    ds_read_b64_tr_b16 v[58:59], v108 offset:1024
    ds_read_b64_tr_b16 v[60:61], v108 offset:8192
    ds_read_b64_tr_b16 v[62:63], v108 offset:9216
    ds_read_b64_tr_b16 v[64:65], v108 offset:16384
    ds_read_b64_tr_b16 v[66:67], v108 offset:17408
    ds_read_b64_tr_b16 v[68:69], v108 offset:24576
    ds_read_b64_tr_b16 v[70:71], v108 offset:25600
    ds_read_b64_tr_b16 v[224:225], v38 offset:32768
    ds_read_b64_tr_b16 v[226:227], v38 offset:33792
    ds_read_b64_tr_b16 v[228:229], v38 offset:40960
    ds_read_b64_tr_b16 v[230:231], v38 offset:41984
    ds_read_b64_tr_b16 v[232:233], v38 offset:49152
    ds_read_b64_tr_b16 v[234:235], v38 offset:50176
    ds_read_b64_tr_b16 v[236:237], v38 offset:57344
    ds_read_b64_tr_b16 v[238:239], v38 offset:58368
    ds_read_b64_tr_b16 v[240:241], v108 offset:32768
    ds_read_b64_tr_b16 v[242:243], v108 offset:33792
    ds_read_b64_tr_b16 v[244:245], v108 offset:40960
    ds_read_b64_tr_b16 v[246:247], v108 offset:41984
    ds_read_b64_tr_b16 v[248:249], v108 offset:49152
    ds_read_b64_tr_b16 v[250:251], v108 offset:50176
    ds_read_b64_tr_b16 v[252:253], v108 offset:57344
    ds_read_b64_tr_b16 v[254:255], v108 offset:58368
    s_waitcnt lgkmcnt(15)
    v_mfma_f32_16x16x32_bf16 v[24:27], v[40:43], v[76:79], 0
    v_mfma_f32_16x16x32_bf16 v[28:31], v[56:59], v[76:79], 0
    v_mfma_f32_16x16x32_bf16 v[24:27], v[44:47], v[80:83], v[24:27]
    v_mfma_f32_16x16x32_bf16 v[28:31], v[60:63], v[80:83], v[28:31]
    v_mfma_f32_16x16x32_bf16 v[24:27], v[48:51], v[84:87], v[24:27]
    v_mfma_f32_16x16x32_bf16 v[28:31], v[64:67], v[84:87], v[28:31]
    v_mfma_f32_16x16x32_bf16 v[24:27], v[52:55], v[88:91], v[24:27]
    v_mfma_f32_16x16x32_bf16 v[28:31], v[68:71], v[88:91], v[28:31]
    s_waitcnt lgkmcnt(0)
    v_mfma_f32_16x16x32_bf16 v[112:115], v[224:227], v[92:95], 0
    v_mfma_f32_16x16x32_bf16 v[116:119], v[240:243], v[92:95], 0
    v_mfma_f32_16x16x32_bf16 v[112:115], v[228:231], v[96:99], v[112:115]
    v_mfma_f32_16x16x32_bf16 v[116:119], v[244:247], v[96:99], v[116:119]
    v_mfma_f32_16x16x32_bf16 v[112:115], v[232:235], v[100:103], v[112:115]
    v_mfma_f32_16x16x32_bf16 v[116:119], v[248:251], v[100:103], v[116:119]
    v_mfma_f32_16x16x32_bf16 v[112:115], v[236:239], v[104:107], v[112:115]
    v_mfma_f32_16x16x32_bf16 v[116:119], v[252:255], v[104:107], v[116:119]
    s_waitcnt lgkmcnt(0)
    s_mul_i32 s76, s76, 0x19660d
    s_add_u32 s76, s76, 0x3c6ef35f
    v_mov_b32 v36, s76
    s_nop 0
    v_cndmask_b32 v16, v24, v28, s[90:91]
    v_cndmask_b32 v17, v25, v29, s[90:91]
    v_cndmask_b32 v18, v26, v30, s[90:91]
    v_cndmask_b32 v19, v27, v31, s[90:91]
    v_bfi_b32 v16, v37, v36, v16
    v_bfi_b32 v17, v37, v36, v17
    v_bfi_b32 v18, v37, v36, v18
    v_bfi_b32 v19, v37, v36, v19
    ds_write_b128 v110, v[16:19] offset:9216
    s_nop 0
    v_cndmask_b32 v20, v112, v116, s[90:91]
    v_cndmask_b32 v21, v113, v117, s[90:91]
    v_cndmask_b32 v22, v114, v118, s[90:91]
    v_cndmask_b32 v23, v115, v119, s[90:91]
    v_bfi_b32 v20, v37, v36, v20
    v_bfi_b32 v21, v37, v36, v21
    v_bfi_b32 v22, v37, v36, v22
    v_bfi_b32 v23, v37, v36, v23
    ds_write_b128 v110, v[20:23] offset:9728
    s_waitcnt lgkmcnt(0)
    s_barrier
    s_cmp_eq_u32 s3, 0
    s_cbranch_scc1 L_x0c
    buffer_load_dwordx4 v[160:163], v7, s[48:51], s79 offen offset:0 nt
    buffer_load_dwordx4 v[164:167], v7, s[48:51], s79 offen offset:1024 nt
    s_waitcnt vmcnt(9)
    buffer_load_dwordx4 v[168:171], v7, s[48:51], s79 offen offset:2048 nt
    s_waitcnt vmcnt(9)
    buffer_load_dwordx4 v[172:175], v7, s[48:51], s79 offen offset:3072 nt
    s_add_u32 s79, s79, 4096
L_x0c:
    s_waitcnt vmcnt(9)
    buffer_load_dwordx4 v[176:179], v7, s[48:51], s79 offen offset:0 nt
    s_waitcnt vmcnt(9)
    buffer_load_dwordx4 v[180:183], v7, s[48:51], s79 offen offset:1024 nt
    s_waitcnt vmcnt(9)
    buffer_load_dwordx4 v[184:187], v7, s[48:51], s79 offen offset:2048 nt
    s_waitcnt vmcnt(9)
    buffer_load_dwordx4 v[188:191], v7, s[48:51], s79 offen offset:3072 nt
    s_add_u32 s79, s79, 28672
    s_waitcnt vmcnt(9)
    buffer_load_dwordx4 v[192:195], v7, s[48:51], s79 offen offset:0 nt
    s_waitcnt vmcnt(9)
    buffer_load_dwordx4 v[196:199], v7, s[48:51], s79 offen offset:1024 nt
    s_waitcnt vmcnt(9)
    buffer_load_dwordx4 v[200:203], v7, s[48:51], s79 offen offset:2048 nt
    s_waitcnt vmcnt(9)
    buffer_load_dwordx4 v[204:207], v7, s[48:51], s79 offen offset:3072 nt
    s_add_u32 s79, s79, 4096
    s_waitcnt vmcnt(9)
    buffer_load_dwordx4 v[208:211], v7, s[48:51], s79 offen offset:0 nt
    s_waitcnt vmcnt(9)
    buffer_load_dwordx4 v[212:215], v7, s[48:51], s79 offen offset:1024 nt
    s_waitcnt vmcnt(9)
    buffer_load_dwordx4 v[216:219], v7, s[48:51], s79 offen offset:2048 nt
    s_waitcnt vmcnt(9)
    buffer_load_dwordx4 v[220:223], v7, s[48:51], s79 offen offset:3072 nt
    s_add_u32 s79, s79, 28672
    s_waitcnt vmcnt(9)
    buffer_load_dwordx4 v[224:227], v7, s[48:51], s79 offen offset:0 nt
    s_waitcnt vmcnt(9)
    buffer_load_dwordx4 v[228:231], v7, s[48:51], s79 offen offset:1024 nt
    s_waitcnt vmcnt(9)
    buffer_load_dwordx4 v[232:235], v7, s[48:51], s79 offen offset:2048 nt
    s_waitcnt vmcnt(9)
    buffer_load_dwordx4 v[236:239], v7, s[48:51], s79 offen offset:3072 nt
    s_add_u32 s79, s79, 4096
    s_waitcnt vmcnt(9)
    buffer_load_dwordx4 v[240:243], v7, s[48:51], s79 offen offset:0 nt
    s_waitcnt vmcnt(9)
    buffer_load_dwordx4 v[244:247], v7, s[48:51], s79 offen offset:1024 nt
    s_waitcnt vmcnt(9)
    buffer_load_dwordx4 v[248:251], v7, s[48:51], s79 offen offset:2048 nt
    s_waitcnt vmcnt(9)
    buffer_load_dwordx4 v[252:255], v7, s[48:51], s79 offen offset:3072 nt
    s_add_u32 s79, s79, 28672
    s_barrier
    v_lshlrev_b32 v36, 4, v2
    ds_read_b128 v[72:75], v36 offset:0
    s_waitcnt lgkmcnt(0)
    v_mov_b32 v40, v42
    v_mov_b32 v41, v43
    v_mov_b32 v42, v44
    v_mov_b32 v43, v45
    v_mov_b32 v44, v46
    v_mov_b32 v45, v47
    v_mov_b32 v46, v48
    v_mov_b32 v47, v49
    v_mov_b32 v48, v50
    v_mov_b32 v49, v51
    v_mov_b32 v50, v52
    v_mov_b32 v51, v53
    v_mov_b32 v52, v54
    v_mov_b32 v53, v55
    v_dot2_f32_bf16 v28, v128, v72, 0
    v_dot2_f32_bf16 v28, v129, v73, v28
    v_dot2_f32_bf16 v28, v130, v74, v28
    v_dot2_f32_bf16 v28, v131, v75, v28
    v_dot2_f32_bf16 v29, v132, v72, 0
    v_dot2_f32_bf16 v29, v133, v73, v29
    v_dot2_f32_bf16 v29, v134, v74, v29
    v_dot2_f32_bf16 v29, v135, v75, v29
    v_dot2_f32_bf16 v30, v136, v72, 0
    v_dot2_f32_bf16 v30, v137, v73, v30
    v_dot2_f32_bf16 v30, v138, v74, v30
    v_dot2_f32_bf16 v30, v139, v75, v30
    v_dot2_f32_bf16 v31, v140, v72, 0
    v_dot2_f32_bf16 v31, v141, v73, v31
    v_dot2_f32_bf16 v31, v142, v74, v31
    v_dot2_f32_bf16 v31, v143, v75, v31
    s_waitcnt vmcnt(4)
    buffer_load_dwordx4 v[128:131], v7, s[48:51], s79 offen offset:0 nt
    v_add_f32_dpp v28, v28, v28 row_mirror row_mask:0xf bank_mask:0x3
    v_add_f32_dpp v28, v29, v29 row_mirror row_mask:0xf bank_mask:0xc
    v_add_f32_dpp v30, v30, v30 row_mirror row_mask:0xf bank_mask:0x3
    v_add_f32_dpp v30, v31, v31 row_mirror row_mask:0xf bank_mask:0xc
    s_nop 0
    v_add_f32_dpp v32, v28, v28 row_half_mirror row_mask:0xf bank_mask:0x5
    v_add_f32_dpp v32, v30, v30 row_half_mirror row_mask:0xf bank_mask:0xa
    v_dot2_f32_bf16 v28, v144, v72, 0
    v_dot2_f32_bf16 v28, v145, v73, v28
    v_dot2_f32_bf16 v28, v146, v74, v28
    v_dot2_f32_bf16 v28, v147, v75, v28
    v_dot2_f32_bf16 v29, v148, v72, 0
    v_dot2_f32_bf16 v29, v149, v73, v29
    v_dot2_f32_bf16 v29, v150, v74, v29
    v_dot2_f32_bf16 v29, v151, v75, v29
    v_dot2_f32_bf16 v30, v152, v72, 0
    v_dot2_f32_bf16 v30, v153, v73, v30
    v_dot2_f32_bf16 v30, v154, v74, v30
    v_dot2_f32_bf16 v30, v155, v75, v30
    v_dot2_f32_bf16 v31, v156, v72, 0
    v_dot2_f32_bf16 v31, v157, v73, v31
    v_dot2_f32_bf16 v31, v158, v74, v31
    v_dot2_f32_bf16 v31, v159, v75, v31
    s_waitcnt vmcnt(4)
    buffer_load_dwordx4 v[132:135], v7, s[48:51], s79 offen offset:1024 nt
    v_add_f32_dpp v28, v28, v28 row_mirror row_mask:0xf bank_mask:0x3
    v_add_f32_dpp v28, v29, v29 row_mirror row_mask:0xf bank_mask:0xc
    v_add_f32_dpp v30, v30, v30 row_mirror row_mask:0xf bank_mask:0x3
    v_add_f32_dpp v30, v31, v31 row_mirror row_mask:0xf bank_mask:0xc
    s_nop 0
    v_add_f32_dpp v33, v28, v28 row_half_mirror row_mask:0xf bank_mask:0x5
    v_add_f32_dpp v33, v30, v30 row_half_mirror row_mask:0xf bank_mask:0xa
    v_dot2_f32_bf16 v28, v160, v72, 0
    v_dot2_f32_bf16 v28, v161, v73, v28
    v_dot2_f32_bf16 v28, v162, v74, v28
    v_dot2_f32_bf16 v28, v163, v75, v28
    v_dot2_f32_bf16 v29, v164, v72, 0
    v_dot2_f32_bf16 v29, v165, v73, v29
    v_dot2_f32_bf16 v29, v166, v74, v29
    v_dot2_f32_bf16 v29, v167, v75, v29
    v_dot2_f32_bf16 v30, v168, v72, 0
    v_dot2_f32_bf16 v30, v169, v73, v30
    v_dot2_f32_bf16 v30, v170, v74, v30
    v_dot2_f32_bf16 v30, v171, v75, v30
    v_dot2_f32_bf16 v31, v172, v72, 0
    v_dot2_f32_bf16 v31, v173, v73, v31
    v_dot2_f32_bf16 v31, v174, v74, v31
    v_dot2_f32_bf16 v31, v175, v75, v31
    s_waitcnt vmcnt(4)
    buffer_load_dwordx4 v[136:139], v7, s[48:51], s79 offen offset:2048 nt
    v_add_f32_dpp v28, v28, v28 row_mirror row_mask:0xf bank_mask:0x3
    v_add_f32_dpp v28, v29, v29 row_mirror row_mask:0xf bank_mask:0xc
    v_add_f32_dpp v30, v30, v30 row_mirror row_mask:0xf bank_mask:0x3
    v_add_f32_dpp v30, v31, v31 row_mirror row_mask:0xf bank_mask:0xc
    s_nop 0
    v_add_f32_dpp v34, v28, v28 row_half_mirror row_mask:0xf bank_mask:0x5
    v_add_f32_dpp v34, v30, v30 row_half_mirror row_mask:0xf bank_mask:0xa
    v_dot2_f32_bf16 v28, v176, v72, 0
    v_dot2_f32_bf16 v28, v177, v73, v28
    v_dot2_f32_bf16 v28, v178, v74, v28
    v_dot2_f32_bf16 v28, v179, v75, v28
    v_dot2_f32_bf16 v29, v180, v72, 0
    v_dot2_f32_bf16 v29, v181, v73, v29
    v_dot2_f32_bf16 v29, v182, v74, v29
    v_dot2_f32_bf16 v29, v183, v75, v29
    v_dot2_f32_bf16 v30, v184, v72, 0
    v_dot2_f32_bf16 v30, v185, v73, v30
    v_dot2_f32_bf16 v30, v186, v74, v30
    v_dot2_f32_bf16 v30, v187, v75, v30
    v_dot2_f32_bf16 v31, v188, v72, 0
    v_dot2_f32_bf16 v31, v189, v73, v31
    v_dot2_f32_bf16 v31, v190, v74, v31
    v_dot2_f32_bf16 v31, v191, v75, v31
    s_waitcnt vmcnt(4)
    buffer_load_dwordx4 v[140:143], v7, s[48:51], s79 offen offset:3072 nt
    s_add_u32 s79, s79, 4096
    v_add_f32_dpp v28, v28, v28 row_mirror row_mask:0xf bank_mask:0x3
    v_add_f32_dpp v28, v29, v29 row_mirror row_mask:0xf bank_mask:0xc
    v_add_f32_dpp v30, v30, v30 row_mirror row_mask:0xf bank_mask:0x3
    v_add_f32_dpp v30, v31, v31 row_mirror row_mask:0xf bank_mask:0xc
    s_nop 0
    v_add_f32_dpp v35, v28, v28 row_half_mirror row_mask:0xf bank_mask:0x5
    v_add_f32_dpp v35, v30, v30 row_half_mirror row_mask:0xf bank_mask:0xa
    v_add_f32_dpp v32, v32, v32 quad_perm:[2,3,0,1] row_mask:0xf bank_mask:0xf
    v_add_f32_dpp v33, v33, v33 quad_perm:[2,3,0,1] row_mask:0xf bank_mask:0xf
    v_add_f32_dpp v34, v34, v34 quad_perm:[2,3,0,1] row_mask:0xf bank_mask:0xf
    v_add_f32_dpp v35, v35, v35 quad_perm:[2,3,0,1] row_mask:0xf bank_mask:0xf
    v_cndmask_b32 v32, v32, v33, s[86:87]
    v_cndmask_b32 v34, v34, v35, s[86:87]
    s_nop 0
    v_add_f32_dpp v32, v32, v32 quad_perm:[1,0,3,2] row_mask:0xf bank_mask:0xf
    v_add_f32_dpp v34, v34, v34 quad_perm:[1,0,3,2] row_mask:0xf bank_mask:0xf
    v_cndmask_b32 v54, v32, v34, s[88:89]
    v_dot2_f32_bf16 v28, v192, v72, 0
    v_dot2_f32_bf16 v28, v193, v73, v28
    v_dot2_f32_bf16 v28, v194, v74, v28
    v_dot2_f32_bf16 v28, v195, v75, v28
    v_dot2_f32_bf16 v29, v196, v72, 0
    v_dot2_f32_bf16 v29, v197, v73, v29
    v_dot2_f32_bf16 v29, v198, v74, v29
    v_dot2_f32_bf16 v29, v199, v75, v29
    v_dot2_f32_bf16 v30, v200, v72, 0
    v_dot2_f32_bf16 v30, v201, v73, v30
    v_dot2_f32_bf16 v30, v202, v74, v30
    v_dot2_f32_bf16 v30, v203, v75, v30
    s_mov_b64 exec, 1
    ds_add_rtn_u32 v122, v111, v120 offset:9152
    s_mov_b64 exec, -1
    v_dot2_f32_bf16 v31, v204, v72, 0
    v_dot2_f32_bf16 v31, v205, v73, v31
    v_dot2_f32_bf16 v31, v206, v74, v31
    v_dot2_f32_bf16 v31, v207, v75, v31
    s_waitcnt vmcnt(4)
    buffer_load_dwordx4 v[144:147], v7, s[48:51], s79 offen offset:0 nt
    v_add_f32_dpp v28, v28, v28 row_mirror row_mask:0xf bank_mask:0x3
    v_add_f32_dpp v28, v29, v29 row_mirror row_mask:0xf bank_mask:0xc
    v_add_f32_dpp v30, v30, v30 row_mirror row_mask:0xf bank_mask:0x3
    v_add_f32_dpp v30, v31, v31 row_mirror row_mask:0xf bank_mask:0xc
    s_nop 0
    v_add_f32_dpp v32, v28, v28 row_half_mirror row_mask:0xf bank_mask:0x5
    v_add_f32_dpp v32, v30, v30 row_half_mirror row_mask:0xf bank_mask:0xa
    v_dot2_f32_bf16 v28, v208, v72, 0
    v_dot2_f32_bf16 v28, v209, v73, v28
    v_dot2_f32_bf16 v28, v210, v74, v28
    v_dot2_f32_bf16 v28, v211, v75, v28
    v_dot2_f32_bf16 v29, v212, v72, 0
    v_dot2_f32_bf16 v29, v213, v73, v29
    v_dot2_f32_bf16 v29, v214, v74, v29
    v_dot2_f32_bf16 v29, v215, v75, v29
    v_dot2_f32_bf16 v30, v216, v72, 0
    v_dot2_f32_bf16 v30, v217, v73, v30
    v_dot2_f32_bf16 v30, v218, v74, v30
    v_dot2_f32_bf16 v30, v219, v75, v30
    v_dot2_f32_bf16 v31, v220, v72, 0
    v_dot2_f32_bf16 v31, v221, v73, v31
    v_dot2_f32_bf16 v31, v222, v74, v31
    v_dot2_f32_bf16 v31, v223, v75, v31
    s_waitcnt vmcnt(4)
    buffer_load_dwordx4 v[148:151], v7, s[48:51], s79 offen offset:1024 nt
    v_add_f32_dpp v28, v28, v28 row_mirror row_mask:0xf bank_mask:0x3
    v_add_f32_dpp v28, v29, v29 row_mirror row_mask:0xf bank_mask:0xc
    v_add_f32_dpp v30, v30, v30 row_mirror row_mask:0xf bank_mask:0x3
    v_add_f32_dpp v30, v31, v31 row_mirror row_mask:0xf bank_mask:0xc
    s_nop 0
    v_add_f32_dpp v33, v28, v28 row_half_mirror row_mask:0xf bank_mask:0x5
    v_add_f32_dpp v33, v30, v30 row_half_mirror row_mask:0xf bank_mask:0xa
    v_dot2_f32_bf16 v28, v224, v72, 0
    v_dot2_f32_bf16 v28, v225, v73, v28
    v_dot2_f32_bf16 v28, v226, v74, v28
    v_dot2_f32_bf16 v28, v227, v75, v28
    v_dot2_f32_bf16 v29, v228, v72, 0
    v_dot2_f32_bf16 v29, v229, v73, v29
    v_dot2_f32_bf16 v29, v230, v74, v29
    v_dot2_f32_bf16 v29, v231, v75, v29
    v_dot2_f32_bf16 v30, v232, v72, 0
    v_dot2_f32_bf16 v30, v233, v73, v30
    v_dot2_f32_bf16 v30, v234, v74, v30
    v_dot2_f32_bf16 v30, v235, v75, v30
    v_dot2_f32_bf16 v31, v236, v72, 0
    v_dot2_f32_bf16 v31, v237, v73, v31
    v_dot2_f32_bf16 v31, v238, v74, v31
    v_dot2_f32_bf16 v31, v239, v75, v31
    s_waitcnt vmcnt(4)
    buffer_load_dwordx4 v[152:155], v7, s[48:51], s79 offen offset:2048 nt
    v_add_f32_dpp v28, v28, v28 row_mirror row_mask:0xf bank_mask:0x3
    v_add_f32_dpp v28, v29, v29 row_mirror row_mask:0xf bank_mask:0xc
    v_add_f32_dpp v30, v30, v30 row_mirror row_mask:0xf bank_mask:0x3
    v_add_f32_dpp v30, v31, v31 row_mirror row_mask:0xf bank_mask:0xc
    s_nop 0
    v_add_f32_dpp v34, v28, v28 row_half_mirror row_mask:0xf bank_mask:0x5
    v_add_f32_dpp v34, v30, v30 row_half_mirror row_mask:0xf bank_mask:0xa
    v_dot2_f32_bf16 v28, v240, v72, 0
    v_dot2_f32_bf16 v28, v241, v73, v28
    v_dot2_f32_bf16 v28, v242, v74, v28
    v_dot2_f32_bf16 v28, v243, v75, v28
    v_dot2_f32_bf16 v29, v244, v72, 0
    v_dot2_f32_bf16 v29, v245, v73, v29
    v_dot2_f32_bf16 v29, v246, v74, v29
    v_dot2_f32_bf16 v29, v247, v75, v29
    ds_read_b32 v121, v111 offset:9156
    v_dot2_f32_bf16 v30, v248, v72, 0
    v_dot2_f32_bf16 v30, v249, v73, v30
    v_dot2_f32_bf16 v30, v250, v74, v30
    v_dot2_f32_bf16 v30, v251, v75, v30
    v_dot2_f32_bf16 v31, v252, v72, 0
    v_dot2_f32_bf16 v31, v253, v73, v31
    v_dot2_f32_bf16 v31, v254, v74, v31
    v_dot2_f32_bf16 v31, v255, v75, v31
    s_waitcnt vmcnt(4)
    buffer_load_dwordx4 v[156:159], v7, s[48:51], s79 offen offset:3072 nt
    s_add_u32 s79, s79, 28672
    v_add_f32_dpp v28, v28, v28 row_mirror row_mask:0xf bank_mask:0x3
    v_add_f32_dpp v28, v29, v29 row_mirror row_mask:0xf bank_mask:0xc
    v_add_f32_dpp v30, v30, v30 row_mirror row_mask:0xf bank_mask:0x3
    v_add_f32_dpp v30, v31, v31 row_mirror row_mask:0xf bank_mask:0xc
    s_nop 0
    v_add_f32_dpp v35, v28, v28 row_half_mirror row_mask:0xf bank_mask:0x5
    v_add_f32_dpp v35, v30, v30 row_half_mirror row_mask:0xf bank_mask:0xa
    v_add_f32_dpp v32, v32, v32 quad_perm:[2,3,0,1] row_mask:0xf bank_mask:0xf
    v_add_f32_dpp v33, v33, v33 quad_perm:[2,3,0,1] row_mask:0xf bank_mask:0xf
    v_add_f32_dpp v34, v34, v34 quad_perm:[2,3,0,1] row_mask:0xf bank_mask:0xf
    v_add_f32_dpp v35, v35, v35 quad_perm:[2,3,0,1] row_mask:0xf bank_mask:0xf
    v_cndmask_b32 v32, v32, v33, s[86:87]
    v_cndmask_b32 v34, v34, v35, s[86:87]
    s_nop 0
    v_add_f32_dpp v32, v32, v32 quad_perm:[1,0,3,2] row_mask:0xf bank_mask:0xf
    v_add_f32_dpp v34, v34, v34 quad_perm:[1,0,3,2] row_mask:0xf bank_mask:0xf
    v_cndmask_b32 v55, v32, v34, s[88:89]
    s_waitcnt lgkmcnt(0)
    v_readfirstlane_b32 s85, v121
    v_readfirstlane_b32 s81, v122
    s_add_u32 s64, s64, 4
    s_nop 0
    s_sub_i32 s81, s81, s64
    s_mul_i32 s81, s81, 12
    s_add_i32 s81, s81, -16
    s_ashr_i32 s81, s81, 2
    s_add_i32 s85, s85, s81
    s_mov_b32 s80, 6
L_k0:
    v_mov_b32 v40, v42
    v_mov_b32 v41, v43
    v_mov_b32 v42, v44
    v_mov_b32 v43, v45
    v_mov_b32 v44, v46
    v_mov_b32 v45, v47
    v_mov_b32 v46, v48
    v_mov_b32 v47, v49
    v_mov_b32 v48, v50
    v_mov_b32 v49, v51
    v_mov_b32 v50, v52
    v_mov_b32 v51, v53
    v_mov_b32 v52, v54
    v_mov_b32 v53, v55
    v_dot2_f32_bf16 v28, v128, v72, 0
    v_dot2_f32_bf16 v28, v129, v73, v28
    v_dot2_f32_bf16 v28, v130, v74, v28
    v_dot2_f32_bf16 v28, v131, v75, v28
    s_cmp_gt_i32 s85, 0
    s_cbranch_scc1 L_u1
    s_waitcnt vmcnt(4)
    s_cmp_ge_i32 s85, 0
    s_cbranch_scc1 L_u1
    s_waitcnt vmcnt(3)
L_u1:
    buffer_load_dwordx4 v[160:163], v7, s[48:51], s79 offen offset:0 nt
    v_dot2_f32_bf16 v29, v132, v72, 0
    v_dot2_f32_bf16 v29, v133, v73, v29
    v_dot2_f32_bf16 v29, v134, v74, v29
    v_dot2_f32_bf16 v29, v135, v75, v29
    s_waitcnt vmcnt(4)
    buffer_load_dwordx4 v[164:167], v7, s[48:51], s79 offen offset:1024 nt
    v_dot2_f32_bf16 v30, v136, v72, 0
    v_dot2_f32_bf16 v30, v137, v73, v30
    v_dot2_f32_bf16 v30, v138, v74, v30
    v_dot2_f32_bf16 v30, v139, v75, v30
    s_cmp_gt_i32 s85, 8
    s_cbranch_scc1 L_u2
    s_waitcnt vmcnt(4)
    s_cmp_ge_i32 s85, -8
    s_cbranch_scc1 L_u2
    s_waitcnt vmcnt(3)
L_u2:
    buffer_load_dwordx4 v[168:171], v7, s[48:51], s79 offen offset:2048 nt
    v_dot2_f32_bf16 v31, v140, v72, 0
    v_dot2_f32_bf16 v31, v141, v73, v31
    v_dot2_f32_bf16 v31, v142, v74, v31
    v_dot2_f32_bf16 v31, v143, v75, v31
    s_waitcnt vmcnt(4)
    buffer_load_dwordx4 v[172:175], v7, s[48:51], s79 offen offset:3072 nt
    s_add_u32 s79, s79, 4096
    v_add_f32_dpp v28, v28, v28 row_mirror row_mask:0xf bank_mask:0x3
    v_add_f32_dpp v28, v29, v29 row_mirror row_mask:0xf bank_mask:0xc
    v_add_f32_dpp v30, v30, v30 row_mirror row_mask:0xf bank_mask:0x3
    v_add_f32_dpp v30, v31, v31 row_mirror row_mask:0xf bank_mask:0xc
    s_nop 0
    v_add_f32_dpp v32, v28, v28 row_half_mirror row_mask:0xf bank_mask:0x5
    v_add_f32_dpp v32, v30, v30 row_half_mirror row_mask:0xf bank_mask:0xa
    v_dot2_f32_bf16 v28, v144, v72, 0
    v_dot2_f32_bf16 v28, v145, v73, v28
    v_dot2_f32_bf16 v28, v146, v74, v28
    v_dot2_f32_bf16 v28, v147, v75, v28
    s_cmp_gt_i32 s85, 4
    s_cbranch_scc1 L_u3
    s_waitcnt vmcnt(4)
    s_cmp_ge_i32 s85, -4
    s_cbranch_scc1 L_u3
    s_waitcnt vmcnt(3)
L_u3:
    buffer_load_dwordx4 v[176:179], v7, s[48:51], s79 offen offset:0 nt
    v_dot2_f32_bf16 v29, v148, v72, 0
    v_dot2_f32_bf16 v29, v149, v73, v29
    v_dot2_f32_bf16 v29, v150, v74, v29
    v_dot2_f32_bf16 v29, v151, v75, v29
    s_waitcnt vmcnt(4)
    buffer_load_dwordx4 v[180:183], v7, s[48:51], s79 offen offset:1024 nt
    v_dot2_f32_bf16 v30, v152, v72, 0
    v_dot2_f32_bf16 v30, v153, v73, v30
    v_dot2_f32_bf16 v30, v154, v74, v30
    v_dot2_f32_bf16 v30, v155, v75, v30
    s_waitcnt vmcnt(4)
    buffer_load_dwordx4 v[184:187], v7, s[48:51], s79 offen offset:2048 nt
    v_dot2_f32_bf16 v31, v156, v72, 0
    v_dot2_f32_bf16 v31, v157, v73, v31
    v_dot2_f32_bf16 v31, v158, v74, v31
    v_dot2_f32_bf16 v31, v159, v75, v31
    s_waitcnt vmcnt(4)
    buffer_load_dwordx4 v[188:191], v7, s[48:51], s79 offen offset:3072 nt
    s_add_u32 s79, s79, 28672
    v_add_f32_dpp v28, v28, v28 row_mirror row_mask:0xf bank_mask:0x3
    v_add_f32_dpp v28, v29, v29 row_mirror row_mask:0xf bank_mask:0xc
    v_add_f32_dpp v30, v30, v30 row_mirror row_mask:0xf bank_mask:0x3
    v_add_f32_dpp v30, v31, v31 row_mirror row_mask:0xf bank_mask:0xc
    s_nop 0
    v_add_f32_dpp v33, v28, v28 row_half_mirror row_mask:0xf bank_mask:0x5
    v_add_f32_dpp v33, v30, v30 row_half_mirror row_mask:0xf bank_mask:0xa
    v_dot2_f32_bf16 v28, v160, v72, 0
    v_dot2_f32_bf16 v28, v161, v73, v28
    v_dot2_f32_bf16 v28, v162, v74, v28
    v_dot2_f32_bf16 v28, v163, v75, v28
    s_cmp_gt_i32 s85, 2
    s_cbranch_scc1 L_u4
    s_waitcnt vmcnt(4)
    s_cmp_ge_i32 s85, -2
    s_cbranch_scc1 L_u4
    s_waitcnt vmcnt(3)
L_u4:
    buffer_load_dwordx4 v[192:195], v7, s[48:51], s79 offen offset:0 nt
    v_dot2_f32_bf16 v29, v164, v72, 0
    v_dot2_f32_bf16 v29, v165, v73, v29
    v_dot2_f32_bf16 v29, v166, v74, v29
    v_dot2_f32_bf16 v29, v167, v75, v29
    s_waitcnt vmcnt(4)
    buffer_load_dwordx4 v[196:199], v7, s[48:51], s79 offen offset:1024 nt
    v_dot2_f32_bf16 v30, v168, v72, 0
    v_dot2_f32_bf16 v30, v169, v73, v30
    v_dot2_f32_bf16 v30, v170, v74, v30
    v_dot2_f32_bf16 v30, v171, v75, v30
    s_cmp_gt_i32 s85, 10
    s_cbranch_scc1 L_u5
    s_waitcnt vmcnt(4)
    s_cmp_ge_i32 s85, -10
    s_cbranch_scc1 L_u5
    s_waitcnt vmcnt(3)
L_u5:
    buffer_load_dwordx4 v[200:203], v7, s[48:51], s79 offen offset:2048 nt
    v_dot2_f32_bf16 v31, v172, v72, 0
    v_dot2_f32_bf16 v31, v173, v73, v31
    v_dot2_f32_bf16 v31, v174, v74, v31
    v_dot2_f32_bf16 v31, v175, v75, v31
    s_waitcnt vmcnt(4)
    buffer_load_dwordx4 v[204:207], v7, s[48:51], s79 offen offset:3072 nt
    s_add_u32 s79, s79, 4096
    v_add_f32_dpp v28, v28, v28 row_mirror row_mask:0xf bank_mask:0x3
    v_add_f32_dpp v28, v29, v29 row_mirror row_mask:0xf bank_mask:0xc
    v_add_f32_dpp v30, v30, v30 row_mirror row_mask:0xf bank_mask:0x3
    v_add_f32_dpp v30, v31, v31 row_mirror row_mask:0xf bank_mask:0xc
    s_nop 0
    v_add_f32_dpp v34, v28, v28 row_half_mirror row_mask:0xf bank_mask:0x5
    v_add_f32_dpp v34, v30, v30 row_half_mirror row_mask:0xf bank_mask:0xa
    v_dot2_f32_bf16 v28, v176, v72, 0
    v_dot2_f32_bf16 v28, v177, v73, v28
    v_dot2_f32_bf16 v28, v178, v74, v28
    v_dot2_f32_bf16 v28, v179, v75, v28
    s_cmp_gt_i32 s85, 6
    s_cbranch_scc1 L_u6
    s_waitcnt vmcnt(4)
    s_cmp_ge_i32 s85, -6
    s_cbranch_scc1 L_u6
    s_waitcnt vmcnt(3)
L_u6:
    buffer_load_dwordx4 v[208:211], v7, s[48:51], s79 offen offset:0 nt
    v_dot2_f32_bf16 v29, v180, v72, 0
    v_dot2_f32_bf16 v29, v181, v73, v29
    v_dot2_f32_bf16 v29, v182, v74, v29
    v_dot2_f32_bf16 v29, v183, v75, v29
    s_waitcnt vmcnt(4)
    buffer_load_dwordx4 v[212:215], v7, s[48:51], s79 offen offset:1024 nt
    v_dot2_f32_bf16 v30, v184, v72, 0
    v_dot2_f32_bf16 v30, v185, v73, v30
    v_dot2_f32_bf16 v30, v186, v74, v30
    v_dot2_f32_bf16 v30, v187, v75, v30
    s_waitcnt vmcnt(4)
    buffer_load_dwordx4 v[216:219], v7, s[48:51], s79 offen offset:2048 nt
    v_dot2_f32_bf16 v31, v188, v72, 0
    v_dot2_f32_bf16 v31, v189, v73, v31
    v_dot2_f32_bf16 v31, v190, v74, v31
    v_dot2_f32_bf16 v31, v191, v75, v31
    s_waitcnt vmcnt(4)
    buffer_load_dwordx4 v[220:223], v7, s[48:51], s79 offen offset:3072 nt
    s_add_u32 s79, s79, 28672
    v_add_f32_dpp v28, v28, v28 row_mirror row_mask:0xf bank_mask:0x3
    v_add_f32_dpp v28, v29, v29 row_mirror row_mask:0xf bank_mask:0xc
    v_add_f32_dpp v30, v30, v30 row_mirror row_mask:0xf bank_mask:0x3
    v_add_f32_dpp v30, v31, v31 row_mirror row_mask:0xf bank_mask:0xc
    s_nop 0
    v_add_f32_dpp v35, v28, v28 row_half_mirror row_mask:0xf bank_mask:0x5
    v_add_f32_dpp v35, v30, v30 row_half_mirror row_mask:0xf bank_mask:0xa
    v_add_f32_dpp v32, v32, v32 quad_perm:[2,3,0,1] row_mask:0xf bank_mask:0xf
    v_add_f32_dpp v33, v33, v33 quad_perm:[2,3,0,1] row_mask:0xf bank_mask:0xf
    v_add_f32_dpp v34, v34, v34 quad_perm:[2,3,0,1] row_mask:0xf bank_mask:0xf
    v_add_f32_dpp v35, v35, v35 quad_perm:[2,3,0,1] row_mask:0xf bank_mask:0xf
    v_cndmask_b32 v32, v32, v33, s[86:87]
    v_cndmask_b32 v34, v34, v35, s[86:87]
    s_nop 0
    v_add_f32_dpp v32, v32, v32 quad_perm:[1,0,3,2] row_mask:0xf bank_mask:0xf
    v_add_f32_dpp v34, v34, v34 quad_perm:[1,0,3,2] row_mask:0xf bank_mask:0xf
    v_cndmask_b32 v54, v32, v34, s[88:89]
    v_dot2_f32_bf16 v28, v192, v72, 0
    v_dot2_f32_bf16 v28, v193, v73, v28
    v_dot2_f32_bf16 v28, v194, v74, v28
    v_dot2_f32_bf16 v28, v195, v75, v28
    s_cmp_gt_i32 s85, 1
    s_cbranch_scc1 L_u7
    s_waitcnt vmcnt(4)
    s_cmp_ge_i32 s85, -1
    s_cbranch_scc1 L_u7
    s_waitcnt vmcnt(3)
L_u7:
    buffer_load_dwordx4 v[224:227], v7, s[48:51], s79 offen offset:0 nt
    v_dot2_f32_bf16 v29, v196, v72, 0
    v_dot2_f32_bf16 v29, v197, v73, v29
    v_dot2_f32_bf16 v29, v198, v74, v29
    v_dot2_f32_bf16 v29, v199, v75, v29
    s_waitcnt vmcnt(4)
    buffer_load_dwordx4 v[228:231], v7, s[48:51], s79 offen offset:1024 nt
    v_dot2_f32_bf16 v30, v200, v72, 0
    v_dot2_f32_bf16 v30, v201, v73, v30
    v_dot2_f32_bf16 v30, v202, v74, v30
    v_dot2_f32_bf16 v30, v203, v75, v30
    s_cmp_gt_i32 s85, 9
    s_cbranch_scc1 L_u8
    s_waitcnt vmcnt(4)
    s_cmp_ge_i32 s85, -9
    s_cbranch_scc1 L_u8
    s_waitcnt vmcnt(3)
L_u8:
    buffer_load_dwordx4 v[232:235], v7, s[48:51], s79 offen offset:2048 nt
    s_mov_b64 exec, 1
    ds_add_rtn_u32 v122, v111, v120 offset:9152
    s_mov_b64 exec, -1
    v_dot2_f32_bf16 v31, v204, v72, 0
    v_dot2_f32_bf16 v31, v205, v73, v31
    v_dot2_f32_bf16 v31, v206, v74, v31
    v_dot2_f32_bf16 v31, v207, v75, v31
    s_waitcnt vmcnt(4)
    buffer_load_dwordx4 v[236:239], v7, s[48:51], s79 offen offset:3072 nt
    s_add_u32 s79, s79, 4096
    v_add_f32_dpp v28, v28, v28 row_mirror row_mask:0xf bank_mask:0x3
    v_add_f32_dpp v28, v29, v29 row_mirror row_mask:0xf bank_mask:0xc
    v_add_f32_dpp v30, v30, v30 row_mirror row_mask:0xf bank_mask:0x3
    v_add_f32_dpp v30, v31, v31 row_mirror row_mask:0xf bank_mask:0xc
    s_nop 0
    v_add_f32_dpp v32, v28, v28 row_half_mirror row_mask:0xf bank_mask:0x5
    v_add_f32_dpp v32, v30, v30 row_half_mirror row_mask:0xf bank_mask:0xa
    v_dot2_f32_bf16 v28, v208, v72, 0
    v_dot2_f32_bf16 v28, v209, v73, v28
    v_dot2_f32_bf16 v28, v210, v74, v28
    v_dot2_f32_bf16 v28, v211, v75, v28
    s_cmp_gt_i32 s85, 5
    s_cbranch_scc1 L_u9
    s_waitcnt vmcnt(4)
    s_cmp_ge_i32 s85, -5
    s_cbranch_scc1 L_u9
    s_waitcnt vmcnt(3)
L_u9:
    buffer_load_dwordx4 v[240:243], v7, s[48:51], s79 offen offset:0 nt
    v_dot2_f32_bf16 v29, v212, v72, 0
    v_dot2_f32_bf16 v29, v213, v73, v29
    v_dot2_f32_bf16 v29, v214, v74, v29
    v_dot2_f32_bf16 v29, v215, v75, v29
    s_waitcnt vmcnt(4)
    buffer_load_dwordx4 v[244:247], v7, s[48:51], s79 offen offset:1024 nt
    v_dot2_f32_bf16 v30, v216, v72, 0
    v_dot2_f32_bf16 v30, v217, v73, v30
    v_dot2_f32_bf16 v30, v218, v74, v30
    v_dot2_f32_bf16 v30, v219, v75, v30
    s_waitcnt vmcnt(4)
    buffer_load_dwordx4 v[248:251], v7, s[48:51], s79 offen offset:2048 nt
    v_dot2_f32_bf16 v31, v220, v72, 0
    v_dot2_f32_bf16 v31, v221, v73, v31
    v_dot2_f32_bf16 v31, v222, v74, v31
    v_dot2_f32_bf16 v31, v223, v75, v31
    s_waitcnt vmcnt(4)
    buffer_load_dwordx4 v[252:255], v7, s[48:51], s79 offen offset:3072 nt
    s_add_u32 s79, s79, 28672
    v_add_f32_dpp v28, v28, v28 row_mirror row_mask:0xf bank_mask:0x3
    v_add_f32_dpp v28, v29, v29 row_mirror row_mask:0xf bank_mask:0xc
    v_add_f32_dpp v30, v30, v30 row_mirror row_mask:0xf bank_mask:0x3
    v_add_f32_dpp v30, v31, v31 row_mirror row_mask:0xf bank_mask:0xc
    s_nop 0
    v_add_f32_dpp v33, v28, v28 row_half_mirror row_mask:0xf bank_mask:0x5
    v_add_f32_dpp v33, v30, v30 row_half_mirror row_mask:0xf bank_mask:0xa
    v_dot2_f32_bf16 v28, v224, v72, 0
    v_dot2_f32_bf16 v28, v225, v73, v28
    v_dot2_f32_bf16 v28, v226, v74, v28
    v_dot2_f32_bf16 v28, v227, v75, v28
    s_cmp_gt_i32 s85, 3
    s_cbranch_scc1 L_u10
    s_waitcnt vmcnt(4)
    s_cmp_ge_i32 s85, -3
    s_cbranch_scc1 L_u10
    s_waitcnt vmcnt(3)
L_u10:
    buffer_load_dwordx4 v[128:131], v7, s[48:51], s79 offen offset:0 nt
    v_dot2_f32_bf16 v29, v228, v72, 0
    v_dot2_f32_bf16 v29, v229, v73, v29
    v_dot2_f32_bf16 v29, v230, v74, v29
    v_dot2_f32_bf16 v29, v231, v75, v29
    s_waitcnt vmcnt(4)
    buffer_load_dwordx4 v[132:135], v7, s[48:51], s79 offen offset:1024 nt
    v_dot2_f32_bf16 v30, v232, v72, 0
    v_dot2_f32_bf16 v30, v233, v73, v30
    v_dot2_f32_bf16 v30, v234, v74, v30
    v_dot2_f32_bf16 v30, v235, v75, v30
    s_cmp_gt_i32 s85, 11
    s_cbranch_scc1 L_u11
    s_waitcnt vmcnt(4)
    s_cmp_ge_i32 s85, -11
    s_cbranch_scc1 L_u11
    s_waitcnt vmcnt(3)
L_u11:
    buffer_load_dwordx4 v[136:139], v7, s[48:51], s79 offen offset:2048 nt
    v_dot2_f32_bf16 v31, v236, v72, 0
    v_dot2_f32_bf16 v31, v237, v73, v31
    v_dot2_f32_bf16 v31, v238, v74, v31
    v_dot2_f32_bf16 v31, v239, v75, v31
    s_waitcnt vmcnt(4)
    buffer_load_dwordx4 v[140:143], v7, s[48:51], s79 offen offset:3072 nt
    s_add_u32 s79, s79, 4096
    v_add_f32_dpp v28, v28, v28 row_mirror row_mask:0xf bank_mask:0x3
    v_add_f32_dpp v28, v29, v29 row_mirror row_mask:0xf bank_mask:0xc
    v_add_f32_dpp v30, v30, v30 row_mirror row_mask:0xf bank_mask:0x3
    v_add_f32_dpp v30, v31, v31 row_mirror row_mask:0xf bank_mask:0xc
    s_nop 0
    v_add_f32_dpp v34, v28, v28 row_half_mirror row_mask:0xf bank_mask:0x5
    v_add_f32_dpp v34, v30, v30 row_half_mirror row_mask:0xf bank_mask:0xa
    v_dot2_f32_bf16 v28, v240, v72, 0
    v_dot2_f32_bf16 v28, v241, v73, v28
    v_dot2_f32_bf16 v28, v242, v74, v28
    v_dot2_f32_bf16 v28, v243, v75, v28
    s_cmp_gt_i32 s85, 7
    s_cbranch_scc1 L_u12
    s_waitcnt vmcnt(4)
    s_cmp_ge_i32 s85, -7
    s_cbranch_scc1 L_u12
    s_waitcnt vmcnt(3)
L_u12:
    buffer_load_dwordx4 v[144:147], v7, s[48:51], s79 offen offset:0 nt
    v_dot2_f32_bf16 v29, v244, v72, 0
    v_dot2_f32_bf16 v29, v245, v73, v29
    v_dot2_f32_bf16 v29, v246, v74, v29
    v_dot2_f32_bf16 v29, v247, v75, v29
    s_waitcnt vmcnt(4)
    buffer_load_dwordx4 v[148:151], v7, s[48:51], s79 offen offset:1024 nt
    ds_read_b32 v121, v111 offset:9156
    v_dot2_f32_bf16 v30, v248, v72, 0
    v_dot2_f32_bf16 v30, v249, v73, v30
    v_dot2_f32_bf16 v30, v250, v74, v30
    v_dot2_f32_bf16 v30, v251, v75, v30
    s_waitcnt vmcnt(4)
    buffer_load_dwordx4 v[152:155], v7, s[48:51], s79 offen offset:2048 nt
    v_dot2_f32_bf16 v31, v252, v72, 0
    v_dot2_f32_bf16 v31, v253, v73, v31
    v_dot2_f32_bf16 v31, v254, v74, v31
    v_dot2_f32_bf16 v31, v255, v75, v31
    s_waitcnt vmcnt(4)
    buffer_load_dwordx4 v[156:159], v7, s[48:51], s79 offen offset:3072 nt
    s_add_u32 s79, s79, 28672
    v_add_f32_dpp v28, v28, v28 row_mirror row_mask:0xf bank_mask:0x3
    v_add_f32_dpp v28, v29, v29 row_mirror row_mask:0xf bank_mask:0xc
    v_add_f32_dpp v30, v30, v30 row_mirror row_mask:0xf bank_mask:0x3
    v_add_f32_dpp v30, v31, v31 row_mirror row_mask:0xf bank_mask:0xc
    s_nop 0
    v_add_f32_dpp v35, v28, v28 row_half_mirror row_mask:0xf bank_mask:0x5
    v_add_f32_dpp v35, v30, v30 row_half_mirror row_mask:0xf bank_mask:0xa
    v_add_f32_dpp v32, v32, v32 quad_perm:[2,3,0,1] row_mask:0xf bank_mask:0xf
    v_add_f32_dpp v33, v33, v33 quad_perm:[2,3,0,1] row_mask:0xf bank_mask:0xf
    v_add_f32_dpp v34, v34, v34 quad_perm:[2,3,0,1] row_mask:0xf bank_mask:0xf
    v_add_f32_dpp v35, v35, v35 quad_perm:[2,3,0,1] row_mask:0xf bank_mask:0xf
    v_cndmask_b32 v32, v32, v33, s[86:87]
    v_cndmask_b32 v34, v34, v35, s[86:87]
    s_nop 0
    v_add_f32_dpp v32, v32, v32 quad_perm:[1,0,3,2] row_mask:0xf bank_mask:0xf
    v_add_f32_dpp v34, v34, v34 quad_perm:[1,0,3,2] row_mask:0xf bank_mask:0xf
    v_cndmask_b32 v55, v32, v34, s[88:89]
    s_waitcnt lgkmcnt(0)
    v_readfirstlane_b32 s85, v121
    v_readfirstlane_b32 s81, v122
    s_add_u32 s64, s64, 4
    s_nop 0
    s_sub_i32 s81, s81, s64
    s_mul_i32 s81, s81, 12
    s_add_i32 s81, s81, -16
    s_ashr_i32 s81, s81, 2
    s_add_i32 s85, s85, s81
    s_sub_u32 s80, s80, 1
    s_cmp_lg_u32 s80, 0
    s_cbranch_scc1 L_k0
    v_mov_b32 v40, v42
    v_mov_b32 v41, v43
    v_mov_b32 v42, v44
    v_mov_b32 v43, v45
    v_mov_b32 v44, v46
    v_mov_b32 v45, v47
    v_mov_b32 v46, v48
    v_mov_b32 v47, v49
    v_mov_b32 v48, v50
    v_mov_b32 v49, v51
    v_mov_b32 v50, v52
    v_mov_b32 v51, v53
    v_mov_b32 v52, v54
    v_mov_b32 v53, v55
    v_dot2_f32_bf16 v28, v128, v72, 0
    v_dot2_f32_bf16 v28, v129, v73, v28
    v_dot2_f32_bf16 v28, v130, v74, v28
    v_dot2_f32_bf16 v28, v131, v75, v28
    s_cmp_gt_i32 s85, 0
    s_cbranch_scc1 L_u13
    s_waitcnt vmcnt(4)
    s_cmp_ge_i32 s85, 0
    s_cbranch_scc1 L_u13
    s_waitcnt vmcnt(3)
L_u13:
    buffer_load_dwordx4 v[160:163], v7, s[48:51], s79 offen offset:0 nt
    v_dot2_f32_bf16 v29, v132, v72, 0
    v_dot2_f32_bf16 v29, v133, v73, v29
    v_dot2_f32_bf16 v29, v134, v74, v29
    v_dot2_f32_bf16 v29, v135, v75, v29
    s_waitcnt vmcnt(4)
    buffer_load_dwordx4 v[164:167], v7, s[48:51], s79 offen offset:1024 nt
    v_dot2_f32_bf16 v30, v136, v72, 0
    v_dot2_f32_bf16 v30, v137, v73, v30
    v_dot2_f32_bf16 v30, v138, v74, v30
    v_dot2_f32_bf16 v30, v139, v75, v30
    s_cmp_gt_i32 s85, 8
    s_cbranch_scc1 L_u14
    s_waitcnt vmcnt(4)
    s_cmp_ge_i32 s85, -8
    s_cbranch_scc1 L_u14
    s_waitcnt vmcnt(3)
L_u14:
    buffer_load_dwordx4 v[168:171], v7, s[48:51], s79 offen offset:2048 nt
    v_dot2_f32_bf16 v31, v140, v72, 0
    v_dot2_f32_bf16 v31, v141, v73, v31
    v_dot2_f32_bf16 v31, v142, v74, v31
    v_dot2_f32_bf16 v31, v143, v75, v31
    s_waitcnt vmcnt(4)
    buffer_load_dwordx4 v[172:175], v7, s[48:51], s79 offen offset:3072 nt
    s_add_u32 s79, s79, 4096
    v_add_f32_dpp v28, v28, v28 row_mirror row_mask:0xf bank_mask:0x3
    v_add_f32_dpp v28, v29, v29 row_mirror row_mask:0xf bank_mask:0xc
    v_add_f32_dpp v30, v30, v30 row_mirror row_mask:0xf bank_mask:0x3
    v_add_f32_dpp v30, v31, v31 row_mirror row_mask:0xf bank_mask:0xc
    s_nop 0
    v_add_f32_dpp v32, v28, v28 row_half_mirror row_mask:0xf bank_mask:0x5
    v_add_f32_dpp v32, v30, v30 row_half_mirror row_mask:0xf bank_mask:0xa
    v_dot2_f32_bf16 v28, v144, v72, 0
    v_dot2_f32_bf16 v28, v145, v73, v28
    v_dot2_f32_bf16 v28, v146, v74, v28
    v_dot2_f32_bf16 v28, v147, v75, v28
    s_cmp_gt_i32 s85, 4
    s_cbranch_scc1 L_u15
    s_waitcnt vmcnt(4)
    s_cmp_ge_i32 s85, -4
    s_cbranch_scc1 L_u15
    s_waitcnt vmcnt(3)
L_u15:
    buffer_load_dwordx4 v[176:179], v7, s[48:51], s79 offen offset:0 nt
    v_dot2_f32_bf16 v29, v148, v72, 0
    v_dot2_f32_bf16 v29, v149, v73, v29
    v_dot2_f32_bf16 v29, v150, v74, v29
    v_dot2_f32_bf16 v29, v151, v75, v29
    s_waitcnt vmcnt(4)
    buffer_load_dwordx4 v[180:183], v7, s[48:51], s79 offen offset:1024 nt
    v_dot2_f32_bf16 v30, v152, v72, 0
    v_dot2_f32_bf16 v30, v153, v73, v30
    v_dot2_f32_bf16 v30, v154, v74, v30
    v_dot2_f32_bf16 v30, v155, v75, v30
    s_waitcnt vmcnt(4)
    buffer_load_dwordx4 v[184:187], v7, s[48:51], s79 offen offset:2048 nt
    v_dot2_f32_bf16 v31, v156, v72, 0
    v_dot2_f32_bf16 v31, v157, v73, v31
    v_dot2_f32_bf16 v31, v158, v74, v31
    v_dot2_f32_bf16 v31, v159, v75, v31
    s_waitcnt vmcnt(4)
    buffer_load_dwordx4 v[188:191], v7, s[48:51], s79 offen offset:3072 nt
    s_add_u32 s79, s79, 28672
    v_add_f32_dpp v28, v28, v28 row_mirror row_mask:0xf bank_mask:0x3
    v_add_f32_dpp v28, v29, v29 row_mirror row_mask:0xf bank_mask:0xc
    v_add_f32_dpp v30, v30, v30 row_mirror row_mask:0xf bank_mask:0x3
    v_add_f32_dpp v30, v31, v31 row_mirror row_mask:0xf bank_mask:0xc
    s_nop 0
    v_add_f32_dpp v33, v28, v28 row_half_mirror row_mask:0xf bank_mask:0x5
    v_add_f32_dpp v33, v30, v30 row_half_mirror row_mask:0xf bank_mask:0xa
    v_dot2_f32_bf16 v28, v160, v72, 0
    v_dot2_f32_bf16 v28, v161, v73, v28
    v_dot2_f32_bf16 v28, v162, v74, v28
    v_dot2_f32_bf16 v28, v163, v75, v28
    s_cmp_gt_i32 s85, 2
    s_cbranch_scc1 L_u16
    s_waitcnt vmcnt(4)
    s_cmp_ge_i32 s85, -2
    s_cbranch_scc1 L_u16
    s_waitcnt vmcnt(3)
L_u16:
    buffer_load_dwordx4 v[192:195], v7, s[48:51], s79 offen offset:0 nt
    v_dot2_f32_bf16 v29, v164, v72, 0
    v_dot2_f32_bf16 v29, v165, v73, v29
    v_dot2_f32_bf16 v29, v166, v74, v29
    v_dot2_f32_bf16 v29, v167, v75, v29
    s_waitcnt vmcnt(4)
    buffer_load_dwordx4 v[196:199], v7, s[48:51], s79 offen offset:1024 nt
    v_dot2_f32_bf16 v30, v168, v72, 0
    v_dot2_f32_bf16 v30, v169, v73, v30
    v_dot2_f32_bf16 v30, v170, v74, v30
    v_dot2_f32_bf16 v30, v171, v75, v30
    s_cmp_gt_i32 s85, 10
    s_cbranch_scc1 L_u17
    s_waitcnt vmcnt(4)
    s_cmp_ge_i32 s85, -10
    s_cbranch_scc1 L_u17
    s_waitcnt vmcnt(3)
L_u17:
    buffer_load_dwordx4 v[200:203], v7, s[48:51], s79 offen offset:2048 nt
    v_dot2_f32_bf16 v31, v172, v72, 0
    v_dot2_f32_bf16 v31, v173, v73, v31
    v_dot2_f32_bf16 v31, v174, v74, v31
    v_dot2_f32_bf16 v31, v175, v75, v31
    s_waitcnt vmcnt(4)
    buffer_load_dwordx4 v[204:207], v7, s[48:51], s79 offen offset:3072 nt
    s_add_u32 s79, s79, 4096
    v_add_f32_dpp v28, v28, v28 row_mirror row_mask:0xf bank_mask:0x3
    v_add_f32_dpp v28, v29, v29 row_mirror row_mask:0xf bank_mask:0xc
    v_add_f32_dpp v30, v30, v30 row_mirror row_mask:0xf bank_mask:0x3
    v_add_f32_dpp v30, v31, v31 row_mirror row_mask:0xf bank_mask:0xc
    s_nop 0
    v_add_f32_dpp v34, v28, v28 row_half_mirror row_mask:0xf bank_mask:0x5
    v_add_f32_dpp v34, v30, v30 row_half_mirror row_mask:0xf bank_mask:0xa
    v_dot2_f32_bf16 v28, v176, v72, 0
    v_dot2_f32_bf16 v28, v177, v73, v28
    v_dot2_f32_bf16 v28, v178, v74, v28
    v_dot2_f32_bf16 v28, v179, v75, v28
    s_cmp_gt_i32 s85, 6
    s_cbranch_scc1 L_u18
    s_waitcnt vmcnt(4)
    s_cmp_ge_i32 s85, -6
    s_cbranch_scc1 L_u18
    s_waitcnt vmcnt(3)
L_u18:
    buffer_load_dwordx4 v[208:211], v7, s[48:51], s79 offen offset:0 nt
    v_dot2_f32_bf16 v29, v180, v72, 0
    v_dot2_f32_bf16 v29, v181, v73, v29
    v_dot2_f32_bf16 v29, v182, v74, v29
    v_dot2_f32_bf16 v29, v183, v75, v29
    s_waitcnt vmcnt(4)
    buffer_load_dwordx4 v[212:215], v7, s[48:51], s79 offen offset:1024 nt
    v_dot2_f32_bf16 v30, v184, v72, 0
    v_dot2_f32_bf16 v30, v185, v73, v30
    v_dot2_f32_bf16 v30, v186, v74, v30
    v_dot2_f32_bf16 v30, v187, v75, v30
    s_waitcnt vmcnt(4)
    buffer_load_dwordx4 v[216:219], v7, s[48:51], s79 offen offset:2048 nt
    v_dot2_f32_bf16 v31, v188, v72, 0
    v_dot2_f32_bf16 v31, v189, v73, v31
    v_dot2_f32_bf16 v31, v190, v74, v31
    v_dot2_f32_bf16 v31, v191, v75, v31
    s_waitcnt vmcnt(4)
    buffer_load_dwordx4 v[220:223], v7, s[48:51], s79 offen offset:3072 nt
    s_add_u32 s79, s79, 28672
    v_add_f32_dpp v28, v28, v28 row_mirror row_mask:0xf bank_mask:0x3
    v_add_f32_dpp v28, v29, v29 row_mirror row_mask:0xf bank_mask:0xc
    v_add_f32_dpp v30, v30, v30 row_mirror row_mask:0xf bank_mask:0x3
    v_add_f32_dpp v30, v31, v31 row_mirror row_mask:0xf bank_mask:0xc
    s_nop 0
    v_add_f32_dpp v35, v28, v28 row_half_mirror row_mask:0xf bank_mask:0x5
    v_add_f32_dpp v35, v30, v30 row_half_mirror row_mask:0xf bank_mask:0xa
    v_add_f32_dpp v32, v32, v32 quad_perm:[2,3,0,1] row_mask:0xf bank_mask:0xf
    v_add_f32_dpp v33, v33, v33 quad_perm:[2,3,0,1] row_mask:0xf bank_mask:0xf
    v_add_f32_dpp v34, v34, v34 quad_perm:[2,3,0,1] row_mask:0xf bank_mask:0xf
    v_add_f32_dpp v35, v35, v35 quad_perm:[2,3,0,1] row_mask:0xf bank_mask:0xf
    v_cndmask_b32 v32, v32, v33, s[86:87]
    v_cndmask_b32 v34, v34, v35, s[86:87]
    s_nop 0
    v_add_f32_dpp v32, v32, v32 quad_perm:[1,0,3,2] row_mask:0xf bank_mask:0xf
    v_add_f32_dpp v34, v34, v34 quad_perm:[1,0,3,2] row_mask:0xf bank_mask:0xf
    v_cndmask_b32 v54, v32, v34, s[88:89]
    v_dot2_f32_bf16 v28, v192, v72, 0
    v_dot2_f32_bf16 v28, v193, v73, v28
    v_dot2_f32_bf16 v28, v194, v74, v28
    v_dot2_f32_bf16 v28, v195, v75, v28
    s_cmp_gt_i32 s85, 1
    s_cbranch_scc1 L_u19
    s_waitcnt vmcnt(4)
    s_cmp_ge_i32 s85, -1
    s_cbranch_scc1 L_u19
    s_waitcnt vmcnt(3)
L_u19:
    buffer_load_dwordx4 v[224:227], v7, s[48:51], s79 offen offset:0 nt
    v_dot2_f32_bf16 v29, v196, v72, 0
    v_dot2_f32_bf16 v29, v197, v73, v29
    v_dot2_f32_bf16 v29, v198, v74, v29
    v_dot2_f32_bf16 v29, v199, v75, v29
    s_waitcnt vmcnt(4)
    buffer_load_dwordx4 v[228:231], v7, s[48:51], s79 offen offset:1024 nt
    v_dot2_f32_bf16 v30, v200, v72, 0
    v_dot2_f32_bf16 v30, v201, v73, v30
    v_dot2_f32_bf16 v30, v202, v74, v30
    v_dot2_f32_bf16 v30, v203, v75, v30
    s_cmp_gt_i32 s85, 9
    s_cbranch_scc1 L_u20
    s_waitcnt vmcnt(4)
    s_cmp_ge_i32 s85, -9
    s_cbranch_scc1 L_u20
    s_waitcnt vmcnt(3)
L_u20:
    buffer_load_dwordx4 v[232:235], v7, s[48:51], s79 offen offset:2048 nt
    s_mov_b64 exec, 1
    ds_add_rtn_u32 v122, v111, v120 offset:9152
    s_mov_b64 exec, -1
    v_dot2_f32_bf16 v31, v204, v72, 0
    v_dot2_f32_bf16 v31, v205, v73, v31
    v_dot2_f32_bf16 v31, v206, v74, v31
    v_dot2_f32_bf16 v31, v207, v75, v31
    s_waitcnt vmcnt(4)
    buffer_load_dwordx4 v[236:239], v7, s[48:51], s79 offen offset:3072 nt
    s_add_u32 s79, s79, 4096
    v_add_f32_dpp v28, v28, v28 row_mirror row_mask:0xf bank_mask:0x3
    v_add_f32_dpp v28, v29, v29 row_mirror row_mask:0xf bank_mask:0xc
    v_add_f32_dpp v30, v30, v30 row_mirror row_mask:0xf bank_mask:0x3
    v_add_f32_dpp v30, v31, v31 row_mirror row_mask:0xf bank_mask:0xc
    s_nop 0
    v_add_f32_dpp v32, v28, v28 row_half_mirror row_mask:0xf bank_mask:0x5
    v_add_f32_dpp v32, v30, v30 row_half_mirror row_mask:0xf bank_mask:0xa
    v_dot2_f32_bf16 v28, v208, v72, 0
    v_dot2_f32_bf16 v28, v209, v73, v28
    v_dot2_f32_bf16 v28, v210, v74, v28
    v_dot2_f32_bf16 v28, v211, v75, v28
    s_cmp_gt_i32 s85, 5
    s_cbranch_scc1 L_u21
    s_waitcnt vmcnt(4)
    s_cmp_ge_i32 s85, -5
    s_cbranch_scc1 L_u21
    s_waitcnt vmcnt(3)
L_u21:
    buffer_load_dwordx4 v[240:243], v7, s[48:51], s79 offen offset:0 nt
    v_dot2_f32_bf16 v29, v212, v72, 0
    v_dot2_f32_bf16 v29, v213, v73, v29
    v_dot2_f32_bf16 v29, v214, v74, v29
    v_dot2_f32_bf16 v29, v215, v75, v29
    s_waitcnt vmcnt(4)
    buffer_load_dwordx4 v[244:247], v7, s[48:51], s79 offen offset:1024 nt
    v_dot2_f32_bf16 v30, v216, v72, 0
    v_dot2_f32_bf16 v30, v217, v73, v30
    v_dot2_f32_bf16 v30, v218, v74, v30
    v_dot2_f32_bf16 v30, v219, v75, v30
    s_waitcnt vmcnt(4)
    buffer_load_dwordx4 v[248:251], v7, s[48:51], s79 offen offset:2048 nt
    v_dot2_f32_bf16 v31, v220, v72, 0
    v_dot2_f32_bf16 v31, v221, v73, v31
    v_dot2_f32_bf16 v31, v222, v74, v31
    v_dot2_f32_bf16 v31, v223, v75, v31
    s_waitcnt vmcnt(4)
    buffer_load_dwordx4 v[252:255], v7, s[48:51], s79 offen offset:3072 nt
    s_add_u32 s79, s79, 28672
    v_add_f32_dpp v28, v28, v28 row_mirror row_mask:0xf bank_mask:0x3
    v_add_f32_dpp v28, v29, v29 row_mirror row_mask:0xf bank_mask:0xc
    v_add_f32_dpp v30, v30, v30 row_mirror row_mask:0xf bank_mask:0x3
    v_add_f32_dpp v30, v31, v31 row_mirror row_mask:0xf bank_mask:0xc
    s_nop 0
    v_add_f32_dpp v33, v28, v28 row_half_mirror row_mask:0xf bank_mask:0x5
    v_add_f32_dpp v33, v30, v30 row_half_mirror row_mask:0xf bank_mask:0xa
    v_dot2_f32_bf16 v28, v224, v72, 0
    v_dot2_f32_bf16 v28, v225, v73, v28
    v_dot2_f32_bf16 v28, v226, v74, v28
    v_dot2_f32_bf16 v28, v227, v75, v28
    s_mov_b32 s79, s93
    s_cmp_gt_i32 s85, 3
    s_cbranch_scc1 L_u22
    s_waitcnt vmcnt(4)
    s_cmp_ge_i32 s85, -3
    s_cbranch_scc1 L_u22
    s_waitcnt vmcnt(3)
L_u22:
    buffer_load_dwordx4 v[128:131], v7, s[52:55], s79 offen offset:0 nt
    v_dot2_f32_bf16 v29, v228, v72, 0
    v_dot2_f32_bf16 v29, v229, v73, v29
    v_dot2_f32_bf16 v29, v230, v74, v29
    v_dot2_f32_bf16 v29, v231, v75, v29
    s_waitcnt vmcnt(4)
    buffer_load_dwordx4 v[132:135], v7, s[52:55], s79 offen offset:1024 nt
    v_dot2_f32_bf16 v30, v232, v72, 0
    v_dot2_f32_bf16 v30, v233, v73, v30
    v_dot2_f32_bf16 v30, v234, v74, v30
    v_dot2_f32_bf16 v30, v235, v75, v30
    s_cmp_gt_i32 s85, 11
    s_cbranch_scc1 L_u23
    s_waitcnt vmcnt(4)
    s_cmp_ge_i32 s85, -11
    s_cbranch_scc1 L_u23
    s_waitcnt vmcnt(3)
L_u23:
    buffer_load_dwordx4 v[136:139], v7, s[52:55], s79 offen offset:2048 nt
    v_dot2_f32_bf16 v31, v236, v72, 0
    v_dot2_f32_bf16 v31, v237, v73, v31
    v_dot2_f32_bf16 v31, v238, v74, v31
    v_dot2_f32_bf16 v31, v239, v75, v31
    s_waitcnt vmcnt(4)
    buffer_load_dwordx4 v[140:143], v7, s[52:55], s79 offen offset:3072 nt
    s_add_u32 s79, s79, 4096
    v_add_f32_dpp v28, v28, v28 row_mirror row_mask:0xf bank_mask:0x3
    v_add_f32_dpp v28, v29, v29 row_mirror row_mask:0xf bank_mask:0xc
    v_add_f32_dpp v30, v30, v30 row_mirror row_mask:0xf bank_mask:0x3
    v_add_f32_dpp v30, v31, v31 row_mirror row_mask:0xf bank_mask:0xc
    s_nop 0
    v_add_f32_dpp v34, v28, v28 row_half_mirror row_mask:0xf bank_mask:0x5
    v_add_f32_dpp v34, v30, v30 row_half_mirror row_mask:0xf bank_mask:0xa
    v_dot2_f32_bf16 v28, v240, v72, 0
    v_dot2_f32_bf16 v28, v241, v73, v28
    v_dot2_f32_bf16 v28, v242, v74, v28
    v_dot2_f32_bf16 v28, v243, v75, v28
    s_cmp_gt_i32 s85, 7
    s_cbranch_scc1 L_u24
    s_waitcnt vmcnt(4)
    s_cmp_ge_i32 s85, -7
    s_cbranch_scc1 L_u24
    s_waitcnt vmcnt(3)
L_u24:
    buffer_load_dwordx4 v[144:147], v7, s[52:55], s79 offen offset:0 nt
    v_dot2_f32_bf16 v29, v244, v72, 0
    v_dot2_f32_bf16 v29, v245, v73, v29
    v_dot2_f32_bf16 v29, v246, v74, v29
    v_dot2_f32_bf16 v29, v247, v75, v29
    s_waitcnt vmcnt(4)
    buffer_load_dwordx4 v[148:151], v7, s[52:55], s79 offen offset:1024 nt
    ds_read_b32 v121, v111 offset:9156
    v_dot2_f32_bf16 v30, v248, v72, 0
    v_dot2_f32_bf16 v30, v249, v73, v30
    v_dot2_f32_bf16 v30, v250, v74, v30
    v_dot2_f32_bf16 v30, v251, v75, v30
    s_waitcnt vmcnt(4)
    buffer_load_dwordx4 v[152:155], v7, s[52:55], s79 offen offset:2048 nt
    v_dot2_f32_bf16 v31, v252, v72, 0
    v_dot2_f32_bf16 v31, v253, v73, v31
    v_dot2_f32_bf16 v31, v254, v74, v31
    v_dot2_f32_bf16 v31, v255, v75, v31
    s_waitcnt vmcnt(4)
    buffer_load_dwordx4 v[156:159], v7, s[52:55], s79 offen offset:3072 nt
    s_add_u32 s79, s79, 28672
    v_add_f32_dpp v28, v28, v28 row_mirror row_mask:0xf bank_mask:0x3
    v_add_f32_dpp v28, v29, v29 row_mirror row_mask:0xf bank_mask:0xc
    v_add_f32_dpp v30, v30, v30 row_mirror row_mask:0xf bank_mask:0x3
    v_add_f32_dpp v30, v31, v31 row_mirror row_mask:0xf bank_mask:0xc
    s_nop 0
    v_add_f32_dpp v35, v28, v28 row_half_mirror row_mask:0xf bank_mask:0x5
    v_add_f32_dpp v35, v30, v30 row_half_mirror row_mask:0xf bank_mask:0xa
    v_add_f32_dpp v32, v32, v32 quad_perm:[2,3,0,1] row_mask:0xf bank_mask:0xf
    v_add_f32_dpp v33, v33, v33 quad_perm:[2,3,0,1] row_mask:0xf bank_mask:0xf
    v_add_f32_dpp v34, v34, v34 quad_perm:[2,3,0,1] row_mask:0xf bank_mask:0xf
    v_add_f32_dpp v35, v35, v35 quad_perm:[2,3,0,1] row_mask:0xf bank_mask:0xf
    v_cndmask_b32 v32, v32, v33, s[86:87]
    v_cndmask_b32 v34, v34, v35, s[86:87]
    s_nop 0
    v_add_f32_dpp v32, v32, v32 quad_perm:[1,0,3,2] row_mask:0xf bank_mask:0xf
    v_add_f32_dpp v34, v34, v34 quad_perm:[1,0,3,2] row_mask:0xf bank_mask:0xf
    v_cndmask_b32 v55, v32, v34, s[88:89]
    s_waitcnt lgkmcnt(0)
    v_readfirstlane_b32 s85, v121
    v_readfirstlane_b32 s81, v122
    s_add_u32 s64, s64, 4
    s_nop 0
    s_sub_i32 s81, s81, s64
    s_mul_i32 s81, s81, 12
    s_add_i32 s81, s81, -16
    s_ashr_i32 s81, s81, 2
    s_add_i32 s85, s85, s81
    v_max3_f32 v37, v40, v41, v42
    v_max3_f32 v37, v37, v43, v44
    v_max3_f32 v37, v37, v45, v46
    v_max3_f32 v37, v37, v47, v48
    v_max3_f32 v37, v37, v49, v50
    v_max3_f32 v37, v37, v51, v52
    v_max3_f32 v37, v37, v53, v54
    v_max_f32 v37, v37, v55
    s_nop 1
    v_max_f32_dpp v37, v37, v37 row_mirror row_mask:0xf bank_mask:0xf
    s_nop 1
    v_max_f32_dpp v37, v37, v37 row_half_mirror row_mask:0xf bank_mask:0xf
    s_nop 1
    v_max_f32_dpp v37, v37, v37 quad_perm:[2,3,0,1] row_mask:0xf bank_mask:0xf
    s_nop 1
    v_max_f32_dpp v37, v37, v37 quad_perm:[1,0,3,2] row_mask:0xf bank_mask:0xf
    s_nop 1
    v_max_f32_dpp v37, v37, v37 row_bcast:15 row_mask:0xa bank_mask:0xf
    s_nop 1
    v_max_f32_dpp v37, v37, v37 row_bcast:31 row_mask:0xc bank_mask:0xf
    s_nop 0
    v_readlane_b32 s92, v37, 63
    v_mov_b32 v36, s83
    s_nop 0
    v_mul_f32 v36, s92, v36
    v_fma_f32 v40, v40, s83, -v36
    v_fma_f32 v41, v41, s83, -v36
    v_fma_f32 v42, v42, s83, -v36
    v_fma_f32 v43, v43, s83, -v36
    v_fma_f32 v44, v44, s83, -v36
    v_fma_f32 v45, v45, s83, -v36
    v_fma_f32 v46, v46, s83, -v36
    v_fma_f32 v47, v47, s83, -v36
    v_fma_f32 v48, v48, s83, -v36
    v_fma_f32 v49, v49, s83, -v36
    v_fma_f32 v50, v50, s83, -v36
    v_fma_f32 v51, v51, s83, -v36
    v_fma_f32 v52, v52, s83, -v36
    v_fma_f32 v53, v53, s83, -v36
    v_fma_f32 v54, v54, s83, -v36
    v_fma_f32 v55, v55, s83, -v36
    v_exp_f32 v40, v40
    v_exp_f32 v41, v41
    v_exp_f32 v42, v42
    v_exp_f32 v43, v43
    v_exp_f32 v44, v44
    v_exp_f32 v45, v45
    v_exp_f32 v46, v46
    v_exp_f32 v47, v47
    v_exp_f32 v48, v48
    v_exp_f32 v49, v49
    v_exp_f32 v50, v50
    v_exp_f32 v51, v51
    v_exp_f32 v52, v52
    v_exp_f32 v53, v53
    v_exp_f32 v54, v54
    v_exp_f32 v55, v55
    v_mov_b32 v12, 0
    v_mov_b32 v13, 0
    v_mov_b32 v14, 0
    v_mov_b32 v15, 0
    v_add_f32 v24, v40, v41
    v_add_f32 v24, v24, v42
    v_add_f32 v24, v24, v43
    v_add_f32 v24, v24, v44
    v_add_f32 v24, v24, v45
    v_add_f32 v24, v24, v46
    v_add_f32 v24, v24, v47
    v_add_f32 v24, v24, v48
    v_add_f32 v24, v24, v49
    v_add_f32 v24, v24, v50
    v_add_f32 v24, v24, v51
    v_add_f32 v24, v24, v52
    v_add_f32 v24, v24, v53
    v_add_f32 v24, v24, v54
    v_add_f32 v24, v24, v55
    v_cvt_pk_bf16_f32 v40, v40, v40
    v_cvt_pk_bf16_f32 v41, v41, v41
    v_cvt_pk_bf16_f32 v42, v42, v42
    v_cvt_pk_bf16_f32 v43, v43, v43
    v_cvt_pk_bf16_f32 v44, v44, v44
    v_cvt_pk_bf16_f32 v45, v45, v45
    v_cvt_pk_bf16_f32 v46, v46, v46
    v_cvt_pk_bf16_f32 v47, v47, v47
    v_cvt_pk_bf16_f32 v48, v48, v48
    v_cvt_pk_bf16_f32 v49, v49, v49
    v_cvt_pk_bf16_f32 v50, v50, v50
    v_cvt_pk_bf16_f32 v51, v51, v51
    v_cvt_pk_bf16_f32 v52, v52, v52
    v_cvt_pk_bf16_f32 v53, v53, v53
    v_cvt_pk_bf16_f32 v54, v54, v54
    v_cvt_pk_bf16_f32 v55, v55, v55
    s_nop 1
    v_add_f32_dpp v24, v24, v24 row_mirror row_mask:0xf bank_mask:0xf
    s_nop 1
    v_add_f32_dpp v24, v24, v24 row_half_mirror row_mask:0xf bank_mask:0xf
    s_nop 1
    v_add_f32_dpp v24, v24, v24 quad_perm:[2,3,0,1] row_mask:0xf bank_mask:0xf
    s_nop 1
    v_add_f32_dpp v24, v24, v24 quad_perm:[1,0,3,2] row_mask:0xf bank_mask:0xf
    s_nop 1
    v_add_f32_dpp v24, v24, v24 row_bcast:15 row_mask:0xa bank_mask:0xf
    s_nop 1
    v_add_f32_dpp v24, v24, v24 row_bcast:31 row_mask:0xc bank_mask:0xf
    s_nop 0
    v_readlane_b32 s94, v24, 63
    v_lshlrev_b32 v4, 5, v2
    v_lshl_add_u32 v4, v3, 4, v4
    s_lshl_b32 s81, s3, 9
    v_add_u32 v4, s81, v4
    s_lshl_b32 s81, s3, 3
    v_mov_b32 v5, s81
    v_mov_b32 v28, s92
    v_mov_b32 v29, s94
    s_mov_b32 s80, 7
L_v0:
    v_and_b32_dpp v16, v40, v8 row_newbcast:0 row_mask:0xf bank_mask:0xf
    v_and_b32_dpp v17, v40, v9 row_newbcast:0 row_mask:0xf bank_mask:0xf
    v_and_b32_dpp v18, v40, v10 row_newbcast:0 row_mask:0xf bank_mask:0xf
    v_and_b32_dpp v19, v40, v11 row_newbcast:0 row_mask:0xf bank_mask:0xf
    v_and_b32_dpp v20, v40, v8 row_newbcast:8 row_mask:0xf bank_mask:0xf
    v_and_b32_dpp v21, v40, v9 row_newbcast:8 row_mask:0xf bank_mask:0xf
    v_and_b32_dpp v22, v40, v10 row_newbcast:8 row_mask:0xf bank_mask:0xf
    v_and_b32_dpp v23, v40, v11 row_newbcast:8 row_mask:0xf bank_mask:0xf
    v_mfma_f32_16x16x32_bf16 v[12:15], v[16:19], v[128:131], v[12:15]
    s_cmp_gt_i32 s85, 0
    s_cbranch_scc1 L_u25
    s_waitcnt vmcnt(4)
    s_cmp_ge_i32 s85, 0
    s_cbranch_scc1 L_u25
    s_waitcnt vmcnt(3)
L_u25:
    buffer_load_dwordx4 v[160:163], v7, s[52:55], s79 offen offset:0 nt
    v_and_b32_dpp v16, v40, v8 row_newbcast:4 row_mask:0xf bank_mask:0xf
    v_and_b32_dpp v17, v40, v9 row_newbcast:4 row_mask:0xf bank_mask:0xf
    v_and_b32_dpp v18, v40, v10 row_newbcast:4 row_mask:0xf bank_mask:0xf
    v_and_b32_dpp v19, v40, v11 row_newbcast:4 row_mask:0xf bank_mask:0xf
    v_mfma_f32_16x16x32_bf16 v[12:15], v[20:23], v[132:135], v[12:15]
    s_waitcnt vmcnt(4)
    buffer_load_dwordx4 v[164:167], v7, s[52:55], s79 offen offset:1024 nt
    v_and_b32_dpp v20, v40, v8 row_newbcast:12 row_mask:0xf bank_mask:0xf
    v_and_b32_dpp v21, v40, v9 row_newbcast:12 row_mask:0xf bank_mask:0xf
    v_and_b32_dpp v22, v40, v10 row_newbcast:12 row_mask:0xf bank_mask:0xf
    v_and_b32_dpp v23, v40, v11 row_newbcast:12 row_mask:0xf bank_mask:0xf
    v_mfma_f32_16x16x32_bf16 v[12:15], v[16:19], v[136:139], v[12:15]
    s_cmp_gt_i32 s85, 8
    s_cbranch_scc1 L_u26
    s_waitcnt vmcnt(4)
    s_cmp_ge_i32 s85, -8
    s_cbranch_scc1 L_u26
    s_waitcnt vmcnt(3)
L_u26:
    buffer_load_dwordx4 v[168:171], v7, s[52:55], s79 offen offset:2048 nt
    v_and_b32_dpp v16, v40, v8 row_newbcast:2 row_mask:0xf bank_mask:0xf
    v_and_b32_dpp v17, v40, v9 row_newbcast:2 row_mask:0xf bank_mask:0xf
    v_and_b32_dpp v18, v40, v10 row_newbcast:2 row_mask:0xf bank_mask:0xf
    v_and_b32_dpp v19, v40, v11 row_newbcast:2 row_mask:0xf bank_mask:0xf
    v_mfma_f32_16x16x32_bf16 v[12:15], v[20:23], v[140:143], v[12:15]
    s_waitcnt vmcnt(4)
    buffer_load_dwordx4 v[172:175], v7, s[52:55], s79 offen offset:3072 nt
    s_add_u32 s79, s79, 4096
    v_and_b32_dpp v20, v40, v8 row_newbcast:10 row_mask:0xf bank_mask:0xf
    v_and_b32_dpp v21, v40, v9 row_newbcast:10 row_mask:0xf bank_mask:0xf
    v_and_b32_dpp v22, v40, v10 row_newbcast:10 row_mask:0xf bank_mask:0xf
    v_and_b32_dpp v23, v40, v11 row_newbcast:10 row_mask:0xf bank_mask:0xf
    v_mfma_f32_16x16x32_bf16 v[12:15], v[16:19], v[144:147], v[12:15]
    s_cmp_gt_i32 s85, 4
    s_cbranch_scc1 L_u27
    s_waitcnt vmcnt(4)
    s_cmp_ge_i32 s85, -4
    s_cbranch_scc1 L_u27
    s_waitcnt vmcnt(3)
L_u27:
    buffer_load_dwordx4 v[176:179], v7, s[52:55], s79 offen offset:0 nt
    v_and_b32_dpp v16, v40, v8 row_newbcast:6 row_mask:0xf bank_mask:0xf
    v_and_b32_dpp v17, v40, v9 row_newbcast:6 row_mask:0xf bank_mask:0xf
    v_and_b32_dpp v18, v40, v10 row_newbcast:6 row_mask:0xf bank_mask:0xf
    v_and_b32_dpp v19, v40, v11 row_newbcast:6 row_mask:0xf bank_mask:0xf
    v_mfma_f32_16x16x32_bf16 v[12:15], v[20:23], v[148:151], v[12:15]
    s_waitcnt vmcnt(4)
    buffer_load_dwordx4 v[180:183], v7, s[52:55], s79 offen offset:1024 nt
    v_and_b32_dpp v20, v40, v8 row_newbcast:14 row_mask:0xf bank_mask:0xf
    v_and_b32_dpp v21, v40, v9 row_newbcast:14 row_mask:0xf bank_mask:0xf
    v_and_b32_dpp v22, v40, v10 row_newbcast:14 row_mask:0xf bank_mask:0xf
    v_and_b32_dpp v23, v40, v11 row_newbcast:14 row_mask:0xf bank_mask:0xf
    v_mfma_f32_16x16x32_bf16 v[12:15], v[16:19], v[152:155], v[12:15]
    s_waitcnt vmcnt(4)
    buffer_load_dwordx4 v[184:187], v7, s[52:55], s79 offen offset:2048 nt
    v_and_b32_dpp v16, v40, v8 row_newbcast:1 row_mask:0xf bank_mask:0xf
    v_and_b32_dpp v17, v40, v9 row_newbcast:1 row_mask:0xf bank_mask:0xf
    v_and_b32_dpp v18, v40, v10 row_newbcast:1 row_mask:0xf bank_mask:0xf
    v_and_b32_dpp v19, v40, v11 row_newbcast:1 row_mask:0xf bank_mask:0xf
    v_mfma_f32_16x16x32_bf16 v[12:15], v[20:23], v[156:159], v[12:15]
    s_waitcnt vmcnt(4)
    buffer_load_dwordx4 v[188:191], v7, s[52:55], s79 offen offset:3072 nt
    s_add_u32 s79, s79, 28672
    v_and_b32_dpp v20, v40, v8 row_newbcast:9 row_mask:0xf bank_mask:0xf
    v_and_b32_dpp v21, v40, v9 row_newbcast:9 row_mask:0xf bank_mask:0xf
    v_and_b32_dpp v22, v40, v10 row_newbcast:9 row_mask:0xf bank_mask:0xf
    v_and_b32_dpp v23, v40, v11 row_newbcast:9 row_mask:0xf bank_mask:0xf
    v_mfma_f32_16x16x32_bf16 v[12:15], v[16:19], v[160:163], v[12:15]
    s_cmp_gt_i32 s85, 2
    s_cbranch_scc1 L_u28
    s_waitcnt vmcnt(4)
    s_cmp_ge_i32 s85, -2
    s_cbranch_scc1 L_u28
    s_waitcnt vmcnt(3)
L_u28:
    buffer_load_dwordx4 v[192:195], v7, s[52:55], s79 offen offset:0 nt
    v_and_b32_dpp v16, v40, v8 row_newbcast:5 row_mask:0xf bank_mask:0xf
    v_and_b32_dpp v17, v40, v9 row_newbcast:5 row_mask:0xf bank_mask:0xf
    v_and_b32_dpp v18, v40, v10 row_newbcast:5 row_mask:0xf bank_mask:0xf
    v_and_b32_dpp v19, v40, v11 row_newbcast:5 row_mask:0xf bank_mask:0xf
    v_mfma_f32_16x16x32_bf16 v[12:15], v[20:23], v[164:167], v[12:15]
    s_waitcnt vmcnt(4)
    buffer_load_dwordx4 v[196:199], v7, s[52:55], s79 offen offset:1024 nt
    v_and_b32_dpp v20, v40, v8 row_newbcast:13 row_mask:0xf bank_mask:0xf
    v_and_b32_dpp v21, v40, v9 row_newbcast:13 row_mask:0xf bank_mask:0xf
    v_and_b32_dpp v22, v40, v10 row_newbcast:13 row_mask:0xf bank_mask:0xf
    v_and_b32_dpp v23, v40, v11 row_newbcast:13 row_mask:0xf bank_mask:0xf
    v_mfma_f32_16x16x32_bf16 v[12:15], v[16:19], v[168:171], v[12:15]
    s_cmp_gt_i32 s85, 10
    s_cbranch_scc1 L_u29
    s_waitcnt vmcnt(4)
    s_cmp_ge_i32 s85, -10
    s_cbranch_scc1 L_u29
    s_waitcnt vmcnt(3)
L_u29:
    buffer_load_dwordx4 v[200:203], v7, s[52:55], s79 offen offset:2048 nt
    v_and_b32_dpp v16, v40, v8 row_newbcast:3 row_mask:0xf bank_mask:0xf
    v_and_b32_dpp v17, v40, v9 row_newbcast:3 row_mask:0xf bank_mask:0xf
    v_and_b32_dpp v18, v40, v10 row_newbcast:3 row_mask:0xf bank_mask:0xf
    v_and_b32_dpp v19, v40, v11 row_newbcast:3 row_mask:0xf bank_mask:0xf
    v_mfma_f32_16x16x32_bf16 v[12:15], v[20:23], v[172:175], v[12:15]
    s_waitcnt vmcnt(4)
    buffer_load_dwordx4 v[204:207], v7, s[52:55], s79 offen offset:3072 nt
    s_add_u32 s79, s79, 4096
    v_and_b32_dpp v20, v40, v8 row_newbcast:11 row_mask:0xf bank_mask:0xf
    v_and_b32_dpp v21, v40, v9 row_newbcast:11 row_mask:0xf bank_mask:0xf
    v_and_b32_dpp v22, v40, v10 row_newbcast:11 row_mask:0xf bank_mask:0xf
    v_and_b32_dpp v23, v40, v11 row_newbcast:11 row_mask:0xf bank_mask:0xf
    v_mfma_f32_16x16x32_bf16 v[12:15], v[16:19], v[176:179], v[12:15]
    s_cmp_gt_i32 s85, 6
    s_cbranch_scc1 L_u30
    s_waitcnt vmcnt(4)
    s_cmp_ge_i32 s85, -6
    s_cbranch_scc1 L_u30
    s_waitcnt vmcnt(3)
L_u30:
    buffer_load_dwordx4 v[208:211], v7, s[52:55], s79 offen offset:0 nt
    v_and_b32_dpp v16, v40, v8 row_newbcast:7 row_mask:0xf bank_mask:0xf
    v_and_b32_dpp v17, v40, v9 row_newbcast:7 row_mask:0xf bank_mask:0xf
    v_and_b32_dpp v18, v40, v10 row_newbcast:7 row_mask:0xf bank_mask:0xf
    v_and_b32_dpp v19, v40, v11 row_newbcast:7 row_mask:0xf bank_mask:0xf
    v_mfma_f32_16x16x32_bf16 v[12:15], v[20:23], v[180:183], v[12:15]
    s_waitcnt vmcnt(4)
    buffer_load_dwordx4 v[212:215], v7, s[52:55], s79 offen offset:1024 nt
    v_and_b32_dpp v20, v40, v8 row_newbcast:15 row_mask:0xf bank_mask:0xf
    v_and_b32_dpp v21, v40, v9 row_newbcast:15 row_mask:0xf bank_mask:0xf
    v_and_b32_dpp v22, v40, v10 row_newbcast:15 row_mask:0xf bank_mask:0xf
    v_and_b32_dpp v23, v40, v11 row_newbcast:15 row_mask:0xf bank_mask:0xf
    v_mfma_f32_16x16x32_bf16 v[12:15], v[16:19], v[184:187], v[12:15]
    s_waitcnt vmcnt(4)
    buffer_load_dwordx4 v[216:219], v7, s[52:55], s79 offen offset:2048 nt
    v_and_b32_dpp v16, v41, v8 row_newbcast:0 row_mask:0xf bank_mask:0xf
    v_and_b32_dpp v17, v41, v9 row_newbcast:0 row_mask:0xf bank_mask:0xf
    v_and_b32_dpp v18, v41, v10 row_newbcast:0 row_mask:0xf bank_mask:0xf
    v_and_b32_dpp v19, v41, v11 row_newbcast:0 row_mask:0xf bank_mask:0xf
    v_mfma_f32_16x16x32_bf16 v[12:15], v[20:23], v[188:191], v[12:15]
    s_waitcnt vmcnt(4)
    buffer_load_dwordx4 v[220:223], v7, s[52:55], s79 offen offset:3072 nt
    s_add_u32 s79, s79, 28672
    v_and_b32_dpp v20, v41, v8 row_newbcast:8 row_mask:0xf bank_mask:0xf
    v_and_b32_dpp v21, v41, v9 row_newbcast:8 row_mask:0xf bank_mask:0xf
    v_and_b32_dpp v22, v41, v10 row_newbcast:8 row_mask:0xf bank_mask:0xf
    v_and_b32_dpp v23, v41, v11 row_newbcast:8 row_mask:0xf bank_mask:0xf
    v_mfma_f32_16x16x32_bf16 v[12:15], v[16:19], v[192:195], v[12:15]
    s_cmp_gt_i32 s85, 1
    s_cbranch_scc1 L_u31
    s_waitcnt vmcnt(4)
    s_cmp_ge_i32 s85, -1
    s_cbranch_scc1 L_u31
    s_waitcnt vmcnt(3)
L_u31:
    buffer_load_dwordx4 v[224:227], v7, s[52:55], s79 offen offset:0 nt
    v_and_b32_dpp v16, v41, v8 row_newbcast:4 row_mask:0xf bank_mask:0xf
    v_and_b32_dpp v17, v41, v9 row_newbcast:4 row_mask:0xf bank_mask:0xf
    v_and_b32_dpp v18, v41, v10 row_newbcast:4 row_mask:0xf bank_mask:0xf
    v_and_b32_dpp v19, v41, v11 row_newbcast:4 row_mask:0xf bank_mask:0xf
    v_mfma_f32_16x16x32_bf16 v[12:15], v[20:23], v[196:199], v[12:15]
    s_waitcnt vmcnt(4)
    buffer_load_dwordx4 v[228:231], v7, s[52:55], s79 offen offset:1024 nt
    v_and_b32_dpp v20, v41, v8 row_newbcast:12 row_mask:0xf bank_mask:0xf
    v_and_b32_dpp v21, v41, v9 row_newbcast:12 row_mask:0xf bank_mask:0xf
    v_and_b32_dpp v22, v41, v10 row_newbcast:12 row_mask:0xf bank_mask:0xf
    v_and_b32_dpp v23, v41, v11 row_newbcast:12 row_mask:0xf bank_mask:0xf
    v_mfma_f32_16x16x32_bf16 v[12:15], v[16:19], v[200:203], v[12:15]
    s_cmp_gt_i32 s85, 9
    s_cbranch_scc1 L_u32
    s_waitcnt vmcnt(4)
    s_cmp_ge_i32 s85, -9
    s_cbranch_scc1 L_u32
    s_waitcnt vmcnt(3)
L_u32:
    buffer_load_dwordx4 v[232:235], v7, s[52:55], s79 offen offset:2048 nt
    s_mov_b64 exec, 1
    ds_add_rtn_u32 v122, v111, v120 offset:9152
    s_mov_b64 exec, -1
    v_and_b32_dpp v16, v41, v8 row_newbcast:2 row_mask:0xf bank_mask:0xf
    v_and_b32_dpp v17, v41, v9 row_newbcast:2 row_mask:0xf bank_mask:0xf
    v_and_b32_dpp v18, v41, v10 row_newbcast:2 row_mask:0xf bank_mask:0xf
    v_and_b32_dpp v19, v41, v11 row_newbcast:2 row_mask:0xf bank_mask:0xf
    v_mfma_f32_16x16x32_bf16 v[12:15], v[20:23], v[204:207], v[12:15]
    s_waitcnt vmcnt(4)
    buffer_load_dwordx4 v[236:239], v7, s[52:55], s79 offen offset:3072 nt
    s_add_u32 s79, s79, 4096
    v_and_b32_dpp v20, v41, v8 row_newbcast:10 row_mask:0xf bank_mask:0xf
    v_and_b32_dpp v21, v41, v9 row_newbcast:10 row_mask:0xf bank_mask:0xf
    v_and_b32_dpp v22, v41, v10 row_newbcast:10 row_mask:0xf bank_mask:0xf
    v_and_b32_dpp v23, v41, v11 row_newbcast:10 row_mask:0xf bank_mask:0xf
    v_mfma_f32_16x16x32_bf16 v[12:15], v[16:19], v[208:211], v[12:15]
    s_cmp_gt_i32 s85, 5
    s_cbranch_scc1 L_u33
    s_waitcnt vmcnt(4)
    s_cmp_ge_i32 s85, -5
    s_cbranch_scc1 L_u33
    s_waitcnt vmcnt(3)
L_u33:
    buffer_load_dwordx4 v[240:243], v7, s[52:55], s79 offen offset:0 nt
    v_and_b32_dpp v16, v41, v8 row_newbcast:6 row_mask:0xf bank_mask:0xf
    v_and_b32_dpp v17, v41, v9 row_newbcast:6 row_mask:0xf bank_mask:0xf
    v_and_b32_dpp v18, v41, v10 row_newbcast:6 row_mask:0xf bank_mask:0xf
    v_and_b32_dpp v19, v41, v11 row_newbcast:6 row_mask:0xf bank_mask:0xf
    v_mfma_f32_16x16x32_bf16 v[12:15], v[20:23], v[212:215], v[12:15]
    s_waitcnt vmcnt(4)
    buffer_load_dwordx4 v[244:247], v7, s[52:55], s79 offen offset:1024 nt
    v_and_b32_dpp v20, v41, v8 row_newbcast:14 row_mask:0xf bank_mask:0xf
    v_and_b32_dpp v21, v41, v9 row_newbcast:14 row_mask:0xf bank_mask:0xf
    v_and_b32_dpp v22, v41, v10 row_newbcast:14 row_mask:0xf bank_mask:0xf
    v_and_b32_dpp v23, v41, v11 row_newbcast:14 row_mask:0xf bank_mask:0xf
    v_mfma_f32_16x16x32_bf16 v[12:15], v[16:19], v[216:219], v[12:15]
    s_waitcnt vmcnt(4)
    buffer_load_dwordx4 v[248:251], v7, s[52:55], s79 offen offset:2048 nt
    v_and_b32_dpp v16, v41, v8 row_newbcast:1 row_mask:0xf bank_mask:0xf
    v_and_b32_dpp v17, v41, v9 row_newbcast:1 row_mask:0xf bank_mask:0xf
    v_and_b32_dpp v18, v41, v10 row_newbcast:1 row_mask:0xf bank_mask:0xf
    v_and_b32_dpp v19, v41, v11 row_newbcast:1 row_mask:0xf bank_mask:0xf
    v_mfma_f32_16x16x32_bf16 v[12:15], v[20:23], v[220:223], v[12:15]
    s_waitcnt vmcnt(4)
    buffer_load_dwordx4 v[252:255], v7, s[52:55], s79 offen offset:3072 nt
    s_add_u32 s79, s79, 28672
    v_and_b32_dpp v20, v41, v8 row_newbcast:9 row_mask:0xf bank_mask:0xf
    v_and_b32_dpp v21, v41, v9 row_newbcast:9 row_mask:0xf bank_mask:0xf
    v_and_b32_dpp v22, v41, v10 row_newbcast:9 row_mask:0xf bank_mask:0xf
    v_and_b32_dpp v23, v41, v11 row_newbcast:9 row_mask:0xf bank_mask:0xf
    v_mfma_f32_16x16x32_bf16 v[12:15], v[16:19], v[224:227], v[12:15]
    s_cmp_gt_i32 s85, 3
    s_cbranch_scc1 L_u34
    s_waitcnt vmcnt(4)
    s_cmp_ge_i32 s85, -3
    s_cbranch_scc1 L_u34
    s_waitcnt vmcnt(3)
L_u34:
    buffer_load_dwordx4 v[128:131], v7, s[52:55], s79 offen offset:0 nt
    v_and_b32_dpp v16, v41, v8 row_newbcast:5 row_mask:0xf bank_mask:0xf
    v_and_b32_dpp v17, v41, v9 row_newbcast:5 row_mask:0xf bank_mask:0xf
    v_and_b32_dpp v18, v41, v10 row_newbcast:5 row_mask:0xf bank_mask:0xf
    v_and_b32_dpp v19, v41, v11 row_newbcast:5 row_mask:0xf bank_mask:0xf
    v_mfma_f32_16x16x32_bf16 v[12:15], v[20:23], v[228:231], v[12:15]
    s_waitcnt vmcnt(4)
    buffer_load_dwordx4 v[132:135], v7, s[52:55], s79 offen offset:1024 nt
    v_and_b32_dpp v20, v41, v8 row_newbcast:13 row_mask:0xf bank_mask:0xf
    v_and_b32_dpp v21, v41, v9 row_newbcast:13 row_mask:0xf bank_mask:0xf
    v_and_b32_dpp v22, v41, v10 row_newbcast:13 row_mask:0xf bank_mask:0xf
    v_and_b32_dpp v23, v41, v11 row_newbcast:13 row_mask:0xf bank_mask:0xf
    v_mfma_f32_16x16x32_bf16 v[12:15], v[16:19], v[232:235], v[12:15]
    s_cmp_gt_i32 s85, 11
    s_cbranch_scc1 L_u35
    s_waitcnt vmcnt(4)
    s_cmp_ge_i32 s85, -11
    s_cbranch_scc1 L_u35
    s_waitcnt vmcnt(3)
L_u35:
    buffer_load_dwordx4 v[136:139], v7, s[52:55], s79 offen offset:2048 nt
    v_and_b32_dpp v16, v41, v8 row_newbcast:3 row_mask:0xf bank_mask:0xf
    v_and_b32_dpp v17, v41, v9 row_newbcast:3 row_mask:0xf bank_mask:0xf
    v_and_b32_dpp v18, v41, v10 row_newbcast:3 row_mask:0xf bank_mask:0xf
    v_and_b32_dpp v19, v41, v11 row_newbcast:3 row_mask:0xf bank_mask:0xf
    v_mfma_f32_16x16x32_bf16 v[12:15], v[20:23], v[236:239], v[12:15]
    s_waitcnt vmcnt(4)
    buffer_load_dwordx4 v[140:143], v7, s[52:55], s79 offen offset:3072 nt
    s_add_u32 s79, s79, 4096
    v_and_b32_dpp v20, v41, v8 row_newbcast:11 row_mask:0xf bank_mask:0xf
    v_and_b32_dpp v21, v41, v9 row_newbcast:11 row_mask:0xf bank_mask:0xf
    v_and_b32_dpp v22, v41, v10 row_newbcast:11 row_mask:0xf bank_mask:0xf
    v_and_b32_dpp v23, v41, v11 row_newbcast:11 row_mask:0xf bank_mask:0xf
    v_mfma_f32_16x16x32_bf16 v[12:15], v[16:19], v[240:243], v[12:15]
    s_cmp_gt_i32 s85, 7
    s_cbranch_scc1 L_u36
    s_waitcnt vmcnt(4)
    s_cmp_ge_i32 s85, -7
    s_cbranch_scc1 L_u36
    s_waitcnt vmcnt(3)
L_u36:
    buffer_load_dwordx4 v[144:147], v7, s[52:55], s79 offen offset:0 nt
    v_and_b32_dpp v16, v41, v8 row_newbcast:7 row_mask:0xf bank_mask:0xf
    v_and_b32_dpp v17, v41, v9 row_newbcast:7 row_mask:0xf bank_mask:0xf
    v_and_b32_dpp v18, v41, v10 row_newbcast:7 row_mask:0xf bank_mask:0xf
    v_and_b32_dpp v19, v41, v11 row_newbcast:7 row_mask:0xf bank_mask:0xf
    v_mfma_f32_16x16x32_bf16 v[12:15], v[20:23], v[244:247], v[12:15]
    s_waitcnt vmcnt(4)
    buffer_load_dwordx4 v[148:151], v7, s[52:55], s79 offen offset:1024 nt
    ds_read_b32 v121, v111 offset:9156
    v_and_b32_dpp v20, v41, v8 row_newbcast:15 row_mask:0xf bank_mask:0xf
    v_and_b32_dpp v21, v41, v9 row_newbcast:15 row_mask:0xf bank_mask:0xf
    v_and_b32_dpp v22, v41, v10 row_newbcast:15 row_mask:0xf bank_mask:0xf
    v_and_b32_dpp v23, v41, v11 row_newbcast:15 row_mask:0xf bank_mask:0xf
    v_mfma_f32_16x16x32_bf16 v[12:15], v[16:19], v[248:251], v[12:15]
    s_waitcnt vmcnt(4)
    buffer_load_dwordx4 v[152:155], v7, s[52:55], s79 offen offset:2048 nt
    s_nop 1
    v_mfma_f32_16x16x32_bf16 v[12:15], v[20:23], v[252:255], v[12:15]
    s_waitcnt vmcnt(4)
    buffer_load_dwordx4 v[156:159], v7, s[52:55], s79 offen offset:3072 nt
    s_add_u32 s79, s79, 28672
    v_mov_b32 v40, v42
    v_mov_b32 v41, v43
    v_mov_b32 v42, v44
    v_mov_b32 v43, v45
    v_mov_b32 v44, v46
    v_mov_b32 v45, v47
    v_mov_b32 v46, v48
    v_mov_b32 v47, v49
    v_mov_b32 v48, v50
    v_mov_b32 v49, v51
    v_mov_b32 v50, v52
    v_mov_b32 v51, v53
    v_mov_b32 v52, v54
    v_mov_b32 v53, v55
    s_waitcnt lgkmcnt(0)
    v_readfirstlane_b32 s85, v121
    v_readfirstlane_b32 s81, v122
    s_add_u32 s64, s64, 4
    s_nop 0
    s_sub_i32 s81, s81, s64
    s_mul_i32 s81, s81, 12
    s_add_i32 s81, s81, -16
    s_ashr_i32 s81, s81, 2
    s_add_i32 s85, s85, s81
    s_sub_u32 s80, s80, 1
    s_cmp_lg_u32 s80, 0
    s_cbranch_scc1 L_v0
    v_and_b32_dpp v16, v40, v8 row_newbcast:0 row_mask:0xf bank_mask:0xf
    v_and_b32_dpp v17, v40, v9 row_newbcast:0 row_mask:0xf bank_mask:0xf
    v_and_b32_dpp v18, v40, v10 row_newbcast:0 row_mask:0xf bank_mask:0xf
    v_and_b32_dpp v19, v40, v11 row_newbcast:0 row_mask:0xf bank_mask:0xf
    v_and_b32_dpp v20, v40, v8 row_newbcast:8 row_mask:0xf bank_mask:0xf
    v_and_b32_dpp v21, v40, v9 row_newbcast:8 row_mask:0xf bank_mask:0xf
    v_and_b32_dpp v22, v40, v10 row_newbcast:8 row_mask:0xf bank_mask:0xf
    v_and_b32_dpp v23, v40, v11 row_newbcast:8 row_mask:0xf bank_mask:0xf
    v_mfma_f32_16x16x32_bf16 v[12:15], v[16:19], v[128:131], v[12:15]
    s_cmp_gt_i32 s85, 0
    s_cbranch_scc1 L_u37
    s_waitcnt vmcnt(4)
    s_cmp_ge_i32 s85, 0
    s_cbranch_scc1 L_u37
    s_waitcnt vmcnt(3)
L_u37:
    buffer_load_dwordx4 v[160:163], v7, s[52:55], s79 offen offset:0 nt
    v_and_b32_dpp v16, v40, v8 row_newbcast:4 row_mask:0xf bank_mask:0xf
    v_and_b32_dpp v17, v40, v9 row_newbcast:4 row_mask:0xf bank_mask:0xf
    v_and_b32_dpp v18, v40, v10 row_newbcast:4 row_mask:0xf bank_mask:0xf
    v_and_b32_dpp v19, v40, v11 row_newbcast:4 row_mask:0xf bank_mask:0xf
    v_mfma_f32_16x16x32_bf16 v[12:15], v[20:23], v[132:135], v[12:15]
    s_waitcnt vmcnt(4)
    buffer_load_dwordx4 v[164:167], v7, s[52:55], s79 offen offset:1024 nt
    v_and_b32_dpp v20, v40, v8 row_newbcast:12 row_mask:0xf bank_mask:0xf
    v_and_b32_dpp v21, v40, v9 row_newbcast:12 row_mask:0xf bank_mask:0xf
    v_and_b32_dpp v22, v40, v10 row_newbcast:12 row_mask:0xf bank_mask:0xf
    v_and_b32_dpp v23, v40, v11 row_newbcast:12 row_mask:0xf bank_mask:0xf
    v_mfma_f32_16x16x32_bf16 v[12:15], v[16:19], v[136:139], v[12:15]
    s_cmp_gt_i32 s85, 8
    s_cbranch_scc1 L_u38
    s_waitcnt vmcnt(4)
    s_cmp_ge_i32 s85, -8
    s_cbranch_scc1 L_u38
    s_waitcnt vmcnt(3)
L_u38:
    buffer_load_dwordx4 v[168:171], v7, s[52:55], s79 offen offset:2048 nt
    v_and_b32_dpp v16, v40, v8 row_newbcast:2 row_mask:0xf bank_mask:0xf
    v_and_b32_dpp v17, v40, v9 row_newbcast:2 row_mask:0xf bank_mask:0xf
    v_and_b32_dpp v18, v40, v10 row_newbcast:2 row_mask:0xf bank_mask:0xf
    v_and_b32_dpp v19, v40, v11 row_newbcast:2 row_mask:0xf bank_mask:0xf
    v_mfma_f32_16x16x32_bf16 v[12:15], v[20:23], v[140:143], v[12:15]
    s_waitcnt vmcnt(4)
    buffer_load_dwordx4 v[172:175], v7, s[52:55], s79 offen offset:3072 nt
    s_add_u32 s79, s79, 4096
    v_and_b32_dpp v20, v40, v8 row_newbcast:10 row_mask:0xf bank_mask:0xf
    v_and_b32_dpp v21, v40, v9 row_newbcast:10 row_mask:0xf bank_mask:0xf
    v_and_b32_dpp v22, v40, v10 row_newbcast:10 row_mask:0xf bank_mask:0xf
    v_and_b32_dpp v23, v40, v11 row_newbcast:10 row_mask:0xf bank_mask:0xf
    v_mfma_f32_16x16x32_bf16 v[12:15], v[16:19], v[144:147], v[12:15]
    s_cmp_gt_i32 s85, 4
    s_cbranch_scc1 L_u39
    s_waitcnt vmcnt(4)
    s_cmp_ge_i32 s85, -4
    s_cbranch_scc1 L_u39
    s_waitcnt vmcnt(3)
L_u39:
    buffer_load_dwordx4 v[176:179], v7, s[52:55], s79 offen offset:0 nt
    v_and_b32_dpp v16, v40, v8 row_newbcast:6 row_mask:0xf bank_mask:0xf
    v_and_b32_dpp v17, v40, v9 row_newbcast:6 row_mask:0xf bank_mask:0xf
    v_and_b32_dpp v18, v40, v10 row_newbcast:6 row_mask:0xf bank_mask:0xf
    v_and_b32_dpp v19, v40, v11 row_newbcast:6 row_mask:0xf bank_mask:0xf
    v_mfma_f32_16x16x32_bf16 v[12:15], v[20:23], v[148:151], v[12:15]
    s_waitcnt vmcnt(4)
    buffer_load_dwordx4 v[180:183], v7, s[52:55], s79 offen offset:1024 nt
    v_and_b32_dpp v20, v40, v8 row_newbcast:14 row_mask:0xf bank_mask:0xf
    v_and_b32_dpp v21, v40, v9 row_newbcast:14 row_mask:0xf bank_mask:0xf
    v_and_b32_dpp v22, v40, v10 row_newbcast:14 row_mask:0xf bank_mask:0xf
    v_and_b32_dpp v23, v40, v11 row_newbcast:14 row_mask:0xf bank_mask:0xf
    v_mfma_f32_16x16x32_bf16 v[12:15], v[16:19], v[152:155], v[12:15]
    s_waitcnt vmcnt(4)
    buffer_load_dwordx4 v[184:187], v7, s[52:55], s79 offen offset:2048 nt
    v_and_b32_dpp v16, v40, v8 row_newbcast:1 row_mask:0xf bank_mask:0xf
    v_and_b32_dpp v17, v40, v9 row_newbcast:1 row_mask:0xf bank_mask:0xf
    v_and_b32_dpp v18, v40, v10 row_newbcast:1 row_mask:0xf bank_mask:0xf
    v_and_b32_dpp v19, v40, v11 row_newbcast:1 row_mask:0xf bank_mask:0xf
    v_mfma_f32_16x16x32_bf16 v[12:15], v[20:23], v[156:159], v[12:15]
    s_waitcnt vmcnt(4)
    buffer_load_dwordx4 v[188:191], v7, s[52:55], s79 offen offset:3072 nt
    s_add_u32 s79, s79, 28672
    v_and_b32_dpp v20, v40, v8 row_newbcast:9 row_mask:0xf bank_mask:0xf
    v_and_b32_dpp v21, v40, v9 row_newbcast:9 row_mask:0xf bank_mask:0xf
    v_and_b32_dpp v22, v40, v10 row_newbcast:9 row_mask:0xf bank_mask:0xf
    v_and_b32_dpp v23, v40, v11 row_newbcast:9 row_mask:0xf bank_mask:0xf
    v_mfma_f32_16x16x32_bf16 v[12:15], v[16:19], v[160:163], v[12:15]
    s_cmp_gt_i32 s85, 2
    s_cbranch_scc1 L_u40
    s_waitcnt vmcnt(4)
    s_cmp_ge_i32 s85, -2
    s_cbranch_scc1 L_u40
    s_waitcnt vmcnt(3)
L_u40:
    buffer_load_dwordx4 v[192:195], v7, s[52:55], s79 offen offset:0 nt
    v_and_b32_dpp v16, v40, v8 row_newbcast:5 row_mask:0xf bank_mask:0xf
    v_and_b32_dpp v17, v40, v9 row_newbcast:5 row_mask:0xf bank_mask:0xf
    v_and_b32_dpp v18, v40, v10 row_newbcast:5 row_mask:0xf bank_mask:0xf
    v_and_b32_dpp v19, v40, v11 row_newbcast:5 row_mask:0xf bank_mask:0xf
    v_mfma_f32_16x16x32_bf16 v[12:15], v[20:23], v[164:167], v[12:15]
    s_waitcnt vmcnt(4)
    buffer_load_dwordx4 v[196:199], v7, s[52:55], s79 offen offset:1024 nt
    v_and_b32_dpp v20, v40, v8 row_newbcast:13 row_mask:0xf bank_mask:0xf
    v_and_b32_dpp v21, v40, v9 row_newbcast:13 row_mask:0xf bank_mask:0xf
    v_and_b32_dpp v22, v40, v10 row_newbcast:13 row_mask:0xf bank_mask:0xf
    v_and_b32_dpp v23, v40, v11 row_newbcast:13 row_mask:0xf bank_mask:0xf
    v_mfma_f32_16x16x32_bf16 v[12:15], v[16:19], v[168:171], v[12:15]
    s_cmp_gt_i32 s85, 10
    s_cbranch_scc1 L_u41
    s_waitcnt vmcnt(4)
    s_cmp_ge_i32 s85, -10
    s_cbranch_scc1 L_u41
    s_waitcnt vmcnt(3)
L_u41:
    buffer_load_dwordx4 v[200:203], v7, s[52:55], s79 offen offset:2048 nt
    v_and_b32_dpp v16, v40, v8 row_newbcast:3 row_mask:0xf bank_mask:0xf
    v_and_b32_dpp v17, v40, v9 row_newbcast:3 row_mask:0xf bank_mask:0xf
    v_and_b32_dpp v18, v40, v10 row_newbcast:3 row_mask:0xf bank_mask:0xf
    v_and_b32_dpp v19, v40, v11 row_newbcast:3 row_mask:0xf bank_mask:0xf
    v_mfma_f32_16x16x32_bf16 v[12:15], v[20:23], v[172:175], v[12:15]
    s_waitcnt vmcnt(4)
    buffer_load_dwordx4 v[204:207], v7, s[52:55], s79 offen offset:3072 nt
    s_add_u32 s79, s79, 4096
    v_and_b32_dpp v20, v40, v8 row_newbcast:11 row_mask:0xf bank_mask:0xf
    v_and_b32_dpp v21, v40, v9 row_newbcast:11 row_mask:0xf bank_mask:0xf
    v_and_b32_dpp v22, v40, v10 row_newbcast:11 row_mask:0xf bank_mask:0xf
    v_and_b32_dpp v23, v40, v11 row_newbcast:11 row_mask:0xf bank_mask:0xf
    v_mfma_f32_16x16x32_bf16 v[12:15], v[16:19], v[176:179], v[12:15]
    s_cmp_gt_i32 s85, 6
    s_cbranch_scc1 L_u42
    s_waitcnt vmcnt(4)
    s_cmp_ge_i32 s85, -6
    s_cbranch_scc1 L_u42
    s_waitcnt vmcnt(3)
L_u42:
    buffer_load_dwordx4 v[208:211], v7, s[52:55], s79 offen offset:0 nt
    v_and_b32_dpp v16, v40, v8 row_newbcast:7 row_mask:0xf bank_mask:0xf
    v_and_b32_dpp v17, v40, v9 row_newbcast:7 row_mask:0xf bank_mask:0xf
    v_and_b32_dpp v18, v40, v10 row_newbcast:7 row_mask:0xf bank_mask:0xf
    v_and_b32_dpp v19, v40, v11 row_newbcast:7 row_mask:0xf bank_mask:0xf
    v_mfma_f32_16x16x32_bf16 v[12:15], v[20:23], v[180:183], v[12:15]
    s_waitcnt vmcnt(4)
    buffer_load_dwordx4 v[212:215], v7, s[52:55], s79 offen offset:1024 nt
    v_and_b32_dpp v20, v40, v8 row_newbcast:15 row_mask:0xf bank_mask:0xf
    v_and_b32_dpp v21, v40, v9 row_newbcast:15 row_mask:0xf bank_mask:0xf
    v_and_b32_dpp v22, v40, v10 row_newbcast:15 row_mask:0xf bank_mask:0xf
    v_and_b32_dpp v23, v40, v11 row_newbcast:15 row_mask:0xf bank_mask:0xf
    v_mfma_f32_16x16x32_bf16 v[12:15], v[16:19], v[184:187], v[12:15]
    s_waitcnt vmcnt(4)
    buffer_load_dwordx4 v[216:219], v7, s[52:55], s79 offen offset:2048 nt
    v_and_b32_dpp v16, v41, v8 row_newbcast:0 row_mask:0xf bank_mask:0xf
    v_and_b32_dpp v17, v41, v9 row_newbcast:0 row_mask:0xf bank_mask:0xf
    v_and_b32_dpp v18, v41, v10 row_newbcast:0 row_mask:0xf bank_mask:0xf
    v_and_b32_dpp v19, v41, v11 row_newbcast:0 row_mask:0xf bank_mask:0xf
    v_mfma_f32_16x16x32_bf16 v[12:15], v[20:23], v[188:191], v[12:15]
    s_waitcnt vmcnt(4)
    buffer_load_dwordx4 v[220:223], v7, s[52:55], s79 offen offset:3072 nt
    s_add_u32 s79, s79, 28672
    v_and_b32_dpp v20, v41, v8 row_newbcast:8 row_mask:0xf bank_mask:0xf
    v_and_b32_dpp v21, v41, v9 row_newbcast:8 row_mask:0xf bank_mask:0xf
    v_and_b32_dpp v22, v41, v10 row_newbcast:8 row_mask:0xf bank_mask:0xf
    v_and_b32_dpp v23, v41, v11 row_newbcast:8 row_mask:0xf bank_mask:0xf
    v_mfma_f32_16x16x32_bf16 v[12:15], v[16:19], v[192:195], v[12:15]
    s_cmp_gt_i32 s85, 1
    s_cbranch_scc1 L_u43
    s_waitcnt vmcnt(4)
    s_cmp_ge_i32 s85, -1
    s_cbranch_scc1 L_u43
    s_waitcnt vmcnt(3)
L_u43:
    buffer_load_dwordx4 v[224:227], v7, s[52:55], s79 offen offset:0 nt
    v_and_b32_dpp v16, v41, v8 row_newbcast:4 row_mask:0xf bank_mask:0xf
    v_and_b32_dpp v17, v41, v9 row_newbcast:4 row_mask:0xf bank_mask:0xf
    v_and_b32_dpp v18, v41, v10 row_newbcast:4 row_mask:0xf bank_mask:0xf
    v_and_b32_dpp v19, v41, v11 row_newbcast:4 row_mask:0xf bank_mask:0xf
    v_mfma_f32_16x16x32_bf16 v[12:15], v[20:23], v[196:199], v[12:15]
    s_waitcnt vmcnt(4)
    buffer_load_dwordx4 v[228:231], v7, s[52:55], s79 offen offset:1024 nt
    v_and_b32_dpp v20, v41, v8 row_newbcast:12 row_mask:0xf bank_mask:0xf
    v_and_b32_dpp v21, v41, v9 row_newbcast:12 row_mask:0xf bank_mask:0xf
    v_and_b32_dpp v22, v41, v10 row_newbcast:12 row_mask:0xf bank_mask:0xf
    v_and_b32_dpp v23, v41, v11 row_newbcast:12 row_mask:0xf bank_mask:0xf
    v_mfma_f32_16x16x32_bf16 v[12:15], v[16:19], v[200:203], v[12:15]
    s_cmp_gt_i32 s85, 9
    s_cbranch_scc1 L_u44
    s_waitcnt vmcnt(4)
    s_cmp_ge_i32 s85, -9
    s_cbranch_scc1 L_u44
    s_waitcnt vmcnt(3)
L_u44:
    buffer_load_dwordx4 v[232:235], v7, s[52:55], s79 offen offset:2048 nt
    s_mov_b64 exec, 1
    ds_add_rtn_u32 v122, v111, v120 offset:9152
    s_mov_b64 exec, -1
    v_and_b32_dpp v16, v41, v8 row_newbcast:2 row_mask:0xf bank_mask:0xf
    v_and_b32_dpp v17, v41, v9 row_newbcast:2 row_mask:0xf bank_mask:0xf
    v_and_b32_dpp v18, v41, v10 row_newbcast:2 row_mask:0xf bank_mask:0xf
    v_and_b32_dpp v19, v41, v11 row_newbcast:2 row_mask:0xf bank_mask:0xf
    v_mfma_f32_16x16x32_bf16 v[12:15], v[20:23], v[204:207], v[12:15]
    s_waitcnt vmcnt(4)
    buffer_load_dwordx4 v[236:239], v7, s[52:55], s79 offen offset:3072 nt
    s_add_u32 s79, s79, 4096
    v_and_b32_dpp v20, v41, v8 row_newbcast:10 row_mask:0xf bank_mask:0xf
    v_and_b32_dpp v21, v41, v9 row_newbcast:10 row_mask:0xf bank_mask:0xf
    v_and_b32_dpp v22, v41, v10 row_newbcast:10 row_mask:0xf bank_mask:0xf
    v_and_b32_dpp v23, v41, v11 row_newbcast:10 row_mask:0xf bank_mask:0xf
    v_mfma_f32_16x16x32_bf16 v[12:15], v[16:19], v[208:211], v[12:15]
    s_cmp_gt_i32 s85, 5
    s_cbranch_scc1 L_u45
    s_waitcnt vmcnt(4)
    s_cmp_ge_i32 s85, -5
    s_cbranch_scc1 L_u45
    s_waitcnt vmcnt(3)
L_u45:
    buffer_load_dwordx4 v[240:243], v7, s[52:55], s79 offen offset:0 nt
    v_and_b32_dpp v16, v41, v8 row_newbcast:6 row_mask:0xf bank_mask:0xf
    v_and_b32_dpp v17, v41, v9 row_newbcast:6 row_mask:0xf bank_mask:0xf
    v_and_b32_dpp v18, v41, v10 row_newbcast:6 row_mask:0xf bank_mask:0xf
    v_and_b32_dpp v19, v41, v11 row_newbcast:6 row_mask:0xf bank_mask:0xf
    v_mfma_f32_16x16x32_bf16 v[12:15], v[20:23], v[212:215], v[12:15]
    s_waitcnt vmcnt(4)
    buffer_load_dwordx4 v[244:247], v7, s[52:55], s79 offen offset:1024 nt
    v_and_b32_dpp v20, v41, v8 row_newbcast:14 row_mask:0xf bank_mask:0xf
    v_and_b32_dpp v21, v41, v9 row_newbcast:14 row_mask:0xf bank_mask:0xf
    v_and_b32_dpp v22, v41, v10 row_newbcast:14 row_mask:0xf bank_mask:0xf
    v_and_b32_dpp v23, v41, v11 row_newbcast:14 row_mask:0xf bank_mask:0xf
    v_mfma_f32_16x16x32_bf16 v[12:15], v[16:19], v[216:219], v[12:15]
    s_waitcnt vmcnt(4)
    buffer_load_dwordx4 v[248:251], v7, s[52:55], s79 offen offset:2048 nt
    v_and_b32_dpp v16, v41, v8 row_newbcast:1 row_mask:0xf bank_mask:0xf
    v_and_b32_dpp v17, v41, v9 row_newbcast:1 row_mask:0xf bank_mask:0xf
    v_and_b32_dpp v18, v41, v10 row_newbcast:1 row_mask:0xf bank_mask:0xf
    v_and_b32_dpp v19, v41, v11 row_newbcast:1 row_mask:0xf bank_mask:0xf
    v_mfma_f32_16x16x32_bf16 v[12:15], v[20:23], v[220:223], v[12:15]
    s_waitcnt vmcnt(4)
    buffer_load_dwordx4 v[252:255], v7, s[52:55], s79 offen offset:3072 nt
    s_add_u32 s79, s79, 28672
    v_and_b32_dpp v20, v41, v8 row_newbcast:9 row_mask:0xf bank_mask:0xf
    v_and_b32_dpp v21, v41, v9 row_newbcast:9 row_mask:0xf bank_mask:0xf
    v_and_b32_dpp v22, v41, v10 row_newbcast:9 row_mask:0xf bank_mask:0xf
    v_and_b32_dpp v23, v41, v11 row_newbcast:9 row_mask:0xf bank_mask:0xf
    v_mfma_f32_16x16x32_bf16 v[12:15], v[16:19], v[224:227], v[12:15]
    s_mov_b32 s79, s93
    s_cmp_gt_i32 s85, 3
    s_cbranch_scc1 L_u46
    s_waitcnt vmcnt(4)
    s_cmp_ge_i32 s85, -3
    s_cbranch_scc1 L_u46
    s_waitcnt vmcnt(3)
L_u46:
    buffer_load_dwordx4 v[128:131], v7, s[56:59], s79 offen offset:0 nt
    v_and_b32_dpp v16, v41, v8 row_newbcast:5 row_mask:0xf bank_mask:0xf
    v_and_b32_dpp v17, v41, v9 row_newbcast:5 row_mask:0xf bank_mask:0xf
    v_and_b32_dpp v18, v41, v10 row_newbcast:5 row_mask:0xf bank_mask:0xf
    v_and_b32_dpp v19, v41, v11 row_newbcast:5 row_mask:0xf bank_mask:0xf
    v_mfma_f32_16x16x32_bf16 v[12:15], v[20:23], v[228:231], v[12:15]
    s_waitcnt vmcnt(4)
    buffer_load_dwordx4 v[132:135], v7, s[56:59], s79 offen offset:1024 nt
    v_and_b32_dpp v20, v41, v8 row_newbcast:13 row_mask:0xf bank_mask:0xf
    v_and_b32_dpp v21, v41, v9 row_newbcast:13 row_mask:0xf bank_mask:0xf
    v_and_b32_dpp v22, v41, v10 row_newbcast:13 row_mask:0xf bank_mask:0xf
    v_and_b32_dpp v23, v41, v11 row_newbcast:13 row_mask:0xf bank_mask:0xf
    v_mfma_f32_16x16x32_bf16 v[12:15], v[16:19], v[232:235], v[12:15]
    s_cmp_gt_i32 s85, 11
    s_cbranch_scc1 L_u47
    s_waitcnt vmcnt(4)
    s_cmp_ge_i32 s85, -11
    s_cbranch_scc1 L_u47
    s_waitcnt vmcnt(3)
L_u47:
    buffer_load_dwordx4 v[136:139], v7, s[56:59], s79 offen offset:2048 nt
    v_and_b32_dpp v16, v41, v8 row_newbcast:3 row_mask:0xf bank_mask:0xf
    v_and_b32_dpp v17, v41, v9 row_newbcast:3 row_mask:0xf bank_mask:0xf
    v_and_b32_dpp v18, v41, v10 row_newbcast:3 row_mask:0xf bank_mask:0xf
    v_and_b32_dpp v19, v41, v11 row_newbcast:3 row_mask:0xf bank_mask:0xf
    v_mfma_f32_16x16x32_bf16 v[12:15], v[20:23], v[236:239], v[12:15]
    s_waitcnt vmcnt(4)
    buffer_load_dwordx4 v[140:143], v7, s[56:59], s79 offen offset:3072 nt
    s_add_u32 s79, s79, 4096
    v_and_b32_dpp v20, v41, v8 row_newbcast:11 row_mask:0xf bank_mask:0xf
    v_and_b32_dpp v21, v41, v9 row_newbcast:11 row_mask:0xf bank_mask:0xf
    v_and_b32_dpp v22, v41, v10 row_newbcast:11 row_mask:0xf bank_mask:0xf
    v_and_b32_dpp v23, v41, v11 row_newbcast:11 row_mask:0xf bank_mask:0xf
    v_mfma_f32_16x16x32_bf16 v[12:15], v[16:19], v[240:243], v[12:15]
    s_cmp_gt_i32 s85, 7
    s_cbranch_scc1 L_u48
    s_waitcnt vmcnt(4)
    s_cmp_ge_i32 s85, -7
    s_cbranch_scc1 L_u48
    s_waitcnt vmcnt(3)
L_u48:
    buffer_load_dwordx4 v[144:147], v7, s[56:59], s79 offen offset:0 nt
    v_and_b32_dpp v16, v41, v8 row_newbcast:7 row_mask:0xf bank_mask:0xf
    v_and_b32_dpp v17, v41, v9 row_newbcast:7 row_mask:0xf bank_mask:0xf
    v_and_b32_dpp v18, v41, v10 row_newbcast:7 row_mask:0xf bank_mask:0xf
    v_and_b32_dpp v19, v41, v11 row_newbcast:7 row_mask:0xf bank_mask:0xf
    v_mfma_f32_16x16x32_bf16 v[12:15], v[20:23], v[244:247], v[12:15]
    s_waitcnt vmcnt(4)
    buffer_load_dwordx4 v[148:151], v7, s[56:59], s79 offen offset:1024 nt
    ds_read_b32 v121, v111 offset:9156
    v_and_b32_dpp v20, v41, v8 row_newbcast:15 row_mask:0xf bank_mask:0xf
    v_and_b32_dpp v21, v41, v9 row_newbcast:15 row_mask:0xf bank_mask:0xf
    v_and_b32_dpp v22, v41, v10 row_newbcast:15 row_mask:0xf bank_mask:0xf
    v_and_b32_dpp v23, v41, v11 row_newbcast:15 row_mask:0xf bank_mask:0xf
    v_mfma_f32_16x16x32_bf16 v[12:15], v[16:19], v[248:251], v[12:15]
    s_waitcnt vmcnt(4)
    buffer_load_dwordx4 v[152:155], v7, s[56:59], s79 offen offset:2048 nt
    s_nop 1
    v_mfma_f32_16x16x32_bf16 v[12:15], v[20:23], v[252:255], v[12:15]
    s_waitcnt vmcnt(4)
    buffer_load_dwordx4 v[156:159], v7, s[56:59], s79 offen offset:3072 nt
    s_add_u32 s79, s79, 28672
    v_mov_b32 v40, v42
    v_mov_b32 v41, v43
    v_mov_b32 v42, v44
    v_mov_b32 v43, v45
    v_mov_b32 v44, v46
    v_mov_b32 v45, v47
    v_mov_b32 v46, v48
    v_mov_b32 v47, v49
    v_mov_b32 v48, v50
    v_mov_b32 v49, v51
    v_mov_b32 v50, v52
    v_mov_b32 v51, v53
    v_mov_b32 v52, v54
    v_mov_b32 v53, v55
    s_waitcnt lgkmcnt(0)
    v_readfirstlane_b32 s85, v121
    v_readfirstlane_b32 s81, v122
    s_add_u32 s64, s64, 4
    s_nop 0
    s_sub_i32 s81, s81, s64
    s_mul_i32 s81, s81, 12
    s_add_i32 s81, s81, -16
    s_ashr_i32 s81, s81, 2
    s_add_i32 s85, s85, s81
    s_mov_b32 exec_hi, 0
    ds_write_b128 v4, v[12:15] offset:512
    s_mov_b32 exec_lo, 1
    ds_write_b64 v5, v[28:29] offset:4608
    s_mov_b64 exec, -1
    v_lshlrev_b32 v36, 4, v2
    ds_read_b128 v[72:75], v36 offset:256
    s_waitcnt lgkmcnt(0)
    s_mov_b32 s80, 7
L_k1:
    v_mov_b32 v40, v42
    v_mov_b32 v41, v43
    v_mov_b32 v42, v44
    v_mov_b32 v43, v45
    v_mov_b32 v44, v46
    v_mov_b32 v45, v47
    v_mov_b32 v46, v48
    v_mov_b32 v47, v49
    v_mov_b32 v48, v50
    v_mov_b32 v49, v51
    v_mov_b32 v50, v52
    v_mov_b32 v51, v53
    v_mov_b32 v52, v54
    v_mov_b32 v53, v55
    v_dot2_f32_bf16 v28, v128, v72, 0
    v_dot2_f32_bf16 v28, v129, v73, v28
    v_dot2_f32_bf16 v28, v130, v74, v28
    v_dot2_f32_bf16 v28, v131, v75, v28
    s_cmp_gt_i32 s85, 0
    s_cbranch_scc1 L_u49
    s_waitcnt vmcnt(4)
    s_cmp_ge_i32 s85, 0
    s_cbranch_scc1 L_u49
    s_waitcnt vmcnt(3)
L_u49:
    buffer_load_dwordx4 v[160:163], v7, s[56:59], s79 offen offset:0 nt
    v_dot2_f32_bf16 v29, v132, v72, 0
    v_dot2_f32_bf16 v29, v133, v73, v29
    v_dot2_f32_bf16 v29, v134, v74, v29
    v_dot2_f32_bf16 v29, v135, v75, v29
    s_waitcnt vmcnt(4)
    buffer_load_dwordx4 v[164:167], v7, s[56:59], s79 offen offset:1024 nt
    v_dot2_f32_bf16 v30, v136, v72, 0
    v_dot2_f32_bf16 v30, v137, v73, v30
    v_dot2_f32_bf16 v30, v138, v74, v30
    v_dot2_f32_bf16 v30, v139, v75, v30
    s_cmp_gt_i32 s85, 8
    s_cbranch_scc1 L_u50
    s_waitcnt vmcnt(4)
    s_cmp_ge_i32 s85, -8
    s_cbranch_scc1 L_u50
    s_waitcnt vmcnt(3)
L_u50:
    buffer_load_dwordx4 v[168:171], v7, s[56:59], s79 offen offset:2048 nt
    v_dot2_f32_bf16 v31, v140, v72, 0
    v_dot2_f32_bf16 v31, v141, v73, v31
    v_dot2_f32_bf16 v31, v142, v74, v31
    v_dot2_f32_bf16 v31, v143, v75, v31
    s_waitcnt vmcnt(4)
    buffer_load_dwordx4 v[172:175], v7, s[56:59], s79 offen offset:3072 nt
    s_add_u32 s79, s79, 4096
    v_add_f32_dpp v28, v28, v28 row_mirror row_mask:0xf bank_mask:0x3
    v_add_f32_dpp v28, v29, v29 row_mirror row_mask:0xf bank_mask:0xc
    v_add_f32_dpp v30, v30, v30 row_mirror row_mask:0xf bank_mask:0x3
    v_add_f32_dpp v30, v31, v31 row_mirror row_mask:0xf bank_mask:0xc
    s_nop 0
    v_add_f32_dpp v32, v28, v28 row_half_mirror row_mask:0xf bank_mask:0x5
    v_add_f32_dpp v32, v30, v30 row_half_mirror row_mask:0xf bank_mask:0xa
    v_dot2_f32_bf16 v28, v144, v72, 0
    v_dot2_f32_bf16 v28, v145, v73, v28
    v_dot2_f32_bf16 v28, v146, v74, v28
    v_dot2_f32_bf16 v28, v147, v75, v28
    s_cmp_gt_i32 s85, 4
    s_cbranch_scc1 L_u51
    s_waitcnt vmcnt(4)
    s_cmp_ge_i32 s85, -4
    s_cbranch_scc1 L_u51
    s_waitcnt vmcnt(3)
L_u51:
    buffer_load_dwordx4 v[176:179], v7, s[56:59], s79 offen offset:0 nt
    v_dot2_f32_bf16 v29, v148, v72, 0
    v_dot2_f32_bf16 v29, v149, v73, v29
    v_dot2_f32_bf16 v29, v150, v74, v29
    v_dot2_f32_bf16 v29, v151, v75, v29
    s_waitcnt vmcnt(4)
    buffer_load_dwordx4 v[180:183], v7, s[56:59], s79 offen offset:1024 nt
    v_dot2_f32_bf16 v30, v152, v72, 0
    v_dot2_f32_bf16 v30, v153, v73, v30
    v_dot2_f32_bf16 v30, v154, v74, v30
    v_dot2_f32_bf16 v30, v155, v75, v30
    s_waitcnt vmcnt(4)
    buffer_load_dwordx4 v[184:187], v7, s[56:59], s79 offen offset:2048 nt
    v_dot2_f32_bf16 v31, v156, v72, 0
    v_dot2_f32_bf16 v31, v157, v73, v31
    v_dot2_f32_bf16 v31, v158, v74, v31
    v_dot2_f32_bf16 v31, v159, v75, v31
    s_waitcnt vmcnt(4)
    buffer_load_dwordx4 v[188:191], v7, s[56:59], s79 offen offset:3072 nt
    s_add_u32 s79, s79, 28672
    v_add_f32_dpp v28, v28, v28 row_mirror row_mask:0xf bank_mask:0x3
    v_add_f32_dpp v28, v29, v29 row_mirror row_mask:0xf bank_mask:0xc
    v_add_f32_dpp v30, v30, v30 row_mirror row_mask:0xf bank_mask:0x3
    v_add_f32_dpp v30, v31, v31 row_mirror row_mask:0xf bank_mask:0xc
    s_nop 0
    v_add_f32_dpp v33, v28, v28 row_half_mirror row_mask:0xf bank_mask:0x5
    v_add_f32_dpp v33, v30, v30 row_half_mirror row_mask:0xf bank_mask:0xa
    v_dot2_f32_bf16 v28, v160, v72, 0
    v_dot2_f32_bf16 v28, v161, v73, v28
    v_dot2_f32_bf16 v28, v162, v74, v28
    v_dot2_f32_bf16 v28, v163, v75, v28
    s_cmp_gt_i32 s85, 2
    s_cbranch_scc1 L_u52
    s_waitcnt vmcnt(4)
    s_cmp_ge_i32 s85, -2
    s_cbranch_scc1 L_u52
    s_waitcnt vmcnt(3)
L_u52:
    buffer_load_dwordx4 v[192:195], v7, s[56:59], s79 offen offset:0 nt
    v_dot2_f32_bf16 v29, v164, v72, 0
    v_dot2_f32_bf16 v29, v165, v73, v29
    v_dot2_f32_bf16 v29, v166, v74, v29
    v_dot2_f32_bf16 v29, v167, v75, v29
    s_waitcnt vmcnt(4)
    buffer_load_dwordx4 v[196:199], v7, s[56:59], s79 offen offset:1024 nt
    v_dot2_f32_bf16 v30, v168, v72, 0
    v_dot2_f32_bf16 v30, v169, v73, v30
    v_dot2_f32_bf16 v30, v170, v74, v30
    v_dot2_f32_bf16 v30, v171, v75, v30
    s_cmp_gt_i32 s85, 10
    s_cbranch_scc1 L_u53
    s_waitcnt vmcnt(4)
    s_cmp_ge_i32 s85, -10
    s_cbranch_scc1 L_u53
    s_waitcnt vmcnt(3)
L_u53:
    buffer_load_dwordx4 v[200:203], v7, s[56:59], s79 offen offset:2048 nt
    v_dot2_f32_bf16 v31, v172, v72, 0
    v_dot2_f32_bf16 v31, v173, v73, v31
    v_dot2_f32_bf16 v31, v174, v74, v31
    v_dot2_f32_bf16 v31, v175, v75, v31
    s_waitcnt vmcnt(4)
    buffer_load_dwordx4 v[204:207], v7, s[56:59], s79 offen offset:3072 nt
    s_add_u32 s79, s79, 4096
    v_add_f32_dpp v28, v28, v28 row_mirror row_mask:0xf bank_mask:0x3
    v_add_f32_dpp v28, v29, v29 row_mirror row_mask:0xf bank_mask:0xc
    v_add_f32_dpp v30, v30, v30 row_mirror row_mask:0xf bank_mask:0x3
    v_add_f32_dpp v30, v31, v31 row_mirror row_mask:0xf bank_mask:0xc
    s_nop 0
    v_add_f32_dpp v34, v28, v28 row_half_mirror row_mask:0xf bank_mask:0x5
    v_add_f32_dpp v34, v30, v30 row_half_mirror row_mask:0xf bank_mask:0xa
    v_dot2_f32_bf16 v28, v176, v72, 0
    v_dot2_f32_bf16 v28, v177, v73, v28
    v_dot2_f32_bf16 v28, v178, v74, v28
    v_dot2_f32_bf16 v28, v179, v75, v28
    s_cmp_gt_i32 s85, 6
    s_cbranch_scc1 L_u54
    s_waitcnt vmcnt(4)
    s_cmp_ge_i32 s85, -6
    s_cbranch_scc1 L_u54
    s_waitcnt vmcnt(3)
L_u54:
    buffer_load_dwordx4 v[208:211], v7, s[56:59], s79 offen offset:0 nt
    v_dot2_f32_bf16 v29, v180, v72, 0
    v_dot2_f32_bf16 v29, v181, v73, v29
    v_dot2_f32_bf16 v29, v182, v74, v29
    v_dot2_f32_bf16 v29, v183, v75, v29
    s_waitcnt vmcnt(4)
    buffer_load_dwordx4 v[212:215], v7, s[56:59], s79 offen offset:1024 nt
    v_dot2_f32_bf16 v30, v184, v72, 0
    v_dot2_f32_bf16 v30, v185, v73, v30
    v_dot2_f32_bf16 v30, v186, v74, v30
    v_dot2_f32_bf16 v30, v187, v75, v30
    s_waitcnt vmcnt(4)
    buffer_load_dwordx4 v[216:219], v7, s[56:59], s79 offen offset:2048 nt
    v_dot2_f32_bf16 v31, v188, v72, 0
    v_dot2_f32_bf16 v31, v189, v73, v31
    v_dot2_f32_bf16 v31, v190, v74, v31
    v_dot2_f32_bf16 v31, v191, v75, v31
    s_waitcnt vmcnt(4)
    buffer_load_dwordx4 v[220:223], v7, s[56:59], s79 offen offset:3072 nt
    s_add_u32 s79, s79, 28672
    v_add_f32_dpp v28, v28, v28 row_mirror row_mask:0xf bank_mask:0x3
    v_add_f32_dpp v28, v29, v29 row_mirror row_mask:0xf bank_mask:0xc
    v_add_f32_dpp v30, v30, v30 row_mirror row_mask:0xf bank_mask:0x3
    v_add_f32_dpp v30, v31, v31 row_mirror row_mask:0xf bank_mask:0xc
    s_nop 0
    v_add_f32_dpp v35, v28, v28 row_half_mirror row_mask:0xf bank_mask:0x5
    v_add_f32_dpp v35, v30, v30 row_half_mirror row_mask:0xf bank_mask:0xa
    v_add_f32_dpp v32, v32, v32 quad_perm:[2,3,0,1] row_mask:0xf bank_mask:0xf
    v_add_f32_dpp v33, v33, v33 quad_perm:[2,3,0,1] row_mask:0xf bank_mask:0xf
    v_add_f32_dpp v34, v34, v34 quad_perm:[2,3,0,1] row_mask:0xf bank_mask:0xf
    v_add_f32_dpp v35, v35, v35 quad_perm:[2,3,0,1] row_mask:0xf bank_mask:0xf
    v_cndmask_b32 v32, v32, v33, s[86:87]
    v_cndmask_b32 v34, v34, v35, s[86:87]
    s_nop 0
    v_add_f32_dpp v32, v32, v32 quad_perm:[1,0,3,2] row_mask:0xf bank_mask:0xf
    v_add_f32_dpp v34, v34, v34 quad_perm:[1,0,3,2] row_mask:0xf bank_mask:0xf
    v_cndmask_b32 v54, v32, v34, s[88:89]
    v_dot2_f32_bf16 v28, v192, v72, 0
    v_dot2_f32_bf16 v28, v193, v73, v28
    v_dot2_f32_bf16 v28, v194, v74, v28
    v_dot2_f32_bf16 v28, v195, v75, v28
    s_cmp_gt_i32 s85, 1
    s_cbranch_scc1 L_u55
    s_waitcnt vmcnt(4)
    s_cmp_ge_i32 s85, -1
    s_cbranch_scc1 L_u55
    s_waitcnt vmcnt(3)
L_u55:
    buffer_load_dwordx4 v[224:227], v7, s[56:59], s79 offen offset:0 nt
    v_dot2_f32_bf16 v29, v196, v72, 0
    v_dot2_f32_bf16 v29, v197, v73, v29
    v_dot2_f32_bf16 v29, v198, v74, v29
    v_dot2_f32_bf16 v29, v199, v75, v29
    s_waitcnt vmcnt(4)
    buffer_load_dwordx4 v[228:231], v7, s[56:59], s79 offen offset:1024 nt
    v_dot2_f32_bf16 v30, v200, v72, 0
    v_dot2_f32_bf16 v30, v201, v73, v30
    v_dot2_f32_bf16 v30, v202, v74, v30
    v_dot2_f32_bf16 v30, v203, v75, v30
    s_cmp_gt_i32 s85, 9
    s_cbranch_scc1 L_u56
    s_waitcnt vmcnt(4)
    s_cmp_ge_i32 s85, -9
    s_cbranch_scc1 L_u56
    s_waitcnt vmcnt(3)
L_u56:
    buffer_load_dwordx4 v[232:235], v7, s[56:59], s79 offen offset:2048 nt
    s_mov_b64 exec, 1
    ds_add_rtn_u32 v122, v111, v120 offset:9152
    s_mov_b64 exec, -1
    v_dot2_f32_bf16 v31, v204, v72, 0
    v_dot2_f32_bf16 v31, v205, v73, v31
    v_dot2_f32_bf16 v31, v206, v74, v31
    v_dot2_f32_bf16 v31, v207, v75, v31
    s_waitcnt vmcnt(4)
    buffer_load_dwordx4 v[236:239], v7, s[56:59], s79 offen offset:3072 nt
    s_add_u32 s79, s79, 4096
    v_add_f32_dpp v28, v28, v28 row_mirror row_mask:0xf bank_mask:0x3
    v_add_f32_dpp v28, v29, v29 row_mirror row_mask:0xf bank_mask:0xc
    v_add_f32_dpp v30, v30, v30 row_mirror row_mask:0xf bank_mask:0x3
    v_add_f32_dpp v30, v31, v31 row_mirror row_mask:0xf bank_mask:0xc
    s_nop 0
    v_add_f32_dpp v32, v28, v28 row_half_mirror row_mask:0xf bank_mask:0x5
    v_add_f32_dpp v32, v30, v30 row_half_mirror row_mask:0xf bank_mask:0xa
    v_dot2_f32_bf16 v28, v208, v72, 0
    v_dot2_f32_bf16 v28, v209, v73, v28
    v_dot2_f32_bf16 v28, v210, v74, v28
    v_dot2_f32_bf16 v28, v211, v75, v28
    s_cmp_gt_i32 s85, 5
    s_cbranch_scc1 L_u57
    s_waitcnt vmcnt(4)
    s_cmp_ge_i32 s85, -5
    s_cbranch_scc1 L_u57
    s_waitcnt vmcnt(3)
L_u57:
    buffer_load_dwordx4 v[240:243], v7, s[56:59], s79 offen offset:0 nt
    v_dot2_f32_bf16 v29, v212, v72, 0
    v_dot2_f32_bf16 v29, v213, v73, v29
    v_dot2_f32_bf16 v29, v214, v74, v29
    v_dot2_f32_bf16 v29, v215, v75, v29
    s_waitcnt vmcnt(4)
    buffer_load_dwordx4 v[244:247], v7, s[56:59], s79 offen offset:1024 nt
    v_dot2_f32_bf16 v30, v216, v72, 0
    v_dot2_f32_bf16 v30, v217, v73, v30
    v_dot2_f32_bf16 v30, v218, v74, v30
    v_dot2_f32_bf16 v30, v219, v75, v30
    s_waitcnt vmcnt(4)
    buffer_load_dwordx4 v[248:251], v7, s[56:59], s79 offen offset:2048 nt
    v_dot2_f32_bf16 v31, v220, v72, 0
    v_dot2_f32_bf16 v31, v221, v73, v31
    v_dot2_f32_bf16 v31, v222, v74, v31
    v_dot2_f32_bf16 v31, v223, v75, v31
    s_waitcnt vmcnt(4)
    buffer_load_dwordx4 v[252:255], v7, s[56:59], s79 offen offset:3072 nt
    s_add_u32 s79, s79, 28672
    v_add_f32_dpp v28, v28, v28 row_mirror row_mask:0xf bank_mask:0x3
    v_add_f32_dpp v28, v29, v29 row_mirror row_mask:0xf bank_mask:0xc
    v_add_f32_dpp v30, v30, v30 row_mirror row_mask:0xf bank_mask:0x3
    v_add_f32_dpp v30, v31, v31 row_mirror row_mask:0xf bank_mask:0xc
    s_nop 0
    v_add_f32_dpp v33, v28, v28 row_half_mirror row_mask:0xf bank_mask:0x5
    v_add_f32_dpp v33, v30, v30 row_half_mirror row_mask:0xf bank_mask:0xa
    v_dot2_f32_bf16 v28, v224, v72, 0
    v_dot2_f32_bf16 v28, v225, v73, v28
    v_dot2_f32_bf16 v28, v226, v74, v28
    v_dot2_f32_bf16 v28, v227, v75, v28
    s_cmp_gt_i32 s85, 3
    s_cbranch_scc1 L_u58
    s_waitcnt vmcnt(4)
    s_cmp_ge_i32 s85, -3
    s_cbranch_scc1 L_u58
    s_waitcnt vmcnt(3)
L_u58:
    buffer_load_dwordx4 v[128:131], v7, s[56:59], s79 offen offset:0 nt
    v_dot2_f32_bf16 v29, v228, v72, 0
    v_dot2_f32_bf16 v29, v229, v73, v29
    v_dot2_f32_bf16 v29, v230, v74, v29
    v_dot2_f32_bf16 v29, v231, v75, v29
    s_waitcnt vmcnt(4)
    buffer_load_dwordx4 v[132:135], v7, s[56:59], s79 offen offset:1024 nt
    v_dot2_f32_bf16 v30, v232, v72, 0
    v_dot2_f32_bf16 v30, v233, v73, v30
    v_dot2_f32_bf16 v30, v234, v74, v30
    v_dot2_f32_bf16 v30, v235, v75, v30
    s_cmp_gt_i32 s85, 11
    s_cbranch_scc1 L_u59
    s_waitcnt vmcnt(4)
    s_cmp_ge_i32 s85, -11
    s_cbranch_scc1 L_u59
    s_waitcnt vmcnt(3)
L_u59:
    buffer_load_dwordx4 v[136:139], v7, s[56:59], s79 offen offset:2048 nt
    v_dot2_f32_bf16 v31, v236, v72, 0
    v_dot2_f32_bf16 v31, v237, v73, v31
    v_dot2_f32_bf16 v31, v238, v74, v31
    v_dot2_f32_bf16 v31, v239, v75, v31
    s_waitcnt vmcnt(4)
    buffer_load_dwordx4 v[140:143], v7, s[56:59], s79 offen offset:3072 nt
    s_add_u32 s79, s79, 4096
    v_add_f32_dpp v28, v28, v28 row_mirror row_mask:0xf bank_mask:0x3
    v_add_f32_dpp v28, v29, v29 row_mirror row_mask:0xf bank_mask:0xc
    v_add_f32_dpp v30, v30, v30 row_mirror row_mask:0xf bank_mask:0x3
    v_add_f32_dpp v30, v31, v31 row_mirror row_mask:0xf bank_mask:0xc
    s_nop 0
    v_add_f32_dpp v34, v28, v28 row_half_mirror row_mask:0xf bank_mask:0x5
    v_add_f32_dpp v34, v30, v30 row_half_mirror row_mask:0xf bank_mask:0xa
    v_dot2_f32_bf16 v28, v240, v72, 0
    v_dot2_f32_bf16 v28, v241, v73, v28
    v_dot2_f32_bf16 v28, v242, v74, v28
    v_dot2_f32_bf16 v28, v243, v75, v28
    s_cmp_gt_i32 s85, 7
    s_cbranch_scc1 L_u60
    s_waitcnt vmcnt(4)
    s_cmp_ge_i32 s85, -7
    s_cbranch_scc1 L_u60
    s_waitcnt vmcnt(3)
L_u60:
    buffer_load_dwordx4 v[144:147], v7, s[56:59], s79 offen offset:0 nt
    v_dot2_f32_bf16 v29, v244, v72, 0
    v_dot2_f32_bf16 v29, v245, v73, v29
    v_dot2_f32_bf16 v29, v246, v74, v29
    v_dot2_f32_bf16 v29, v247, v75, v29
    s_waitcnt vmcnt(4)
    buffer_load_dwordx4 v[148:151], v7, s[56:59], s79 offen offset:1024 nt
    ds_read_b32 v121, v111 offset:9156
    v_dot2_f32_bf16 v30, v248, v72, 0
    v_dot2_f32_bf16 v30, v249, v73, v30
    v_dot2_f32_bf16 v30, v250, v74, v30
    v_dot2_f32_bf16 v30, v251, v75, v30
    s_waitcnt vmcnt(4)
    buffer_load_dwordx4 v[152:155], v7, s[56:59], s79 offen offset:2048 nt
    v_dot2_f32_bf16 v31, v252, v72, 0
    v_dot2_f32_bf16 v31, v253, v73, v31
    v_dot2_f32_bf16 v31, v254, v74, v31
    v_dot2_f32_bf16 v31, v255, v75, v31
    s_waitcnt vmcnt(4)
    buffer_load_dwordx4 v[156:159], v7, s[56:59], s79 offen offset:3072 nt
    s_add_u32 s79, s79, 28672
    v_add_f32_dpp v28, v28, v28 row_mirror row_mask:0xf bank_mask:0x3
    v_add_f32_dpp v28, v29, v29 row_mirror row_mask:0xf bank_mask:0xc
    v_add_f32_dpp v30, v30, v30 row_mirror row_mask:0xf bank_mask:0x3
    v_add_f32_dpp v30, v31, v31 row_mirror row_mask:0xf bank_mask:0xc
    s_nop 0
    v_add_f32_dpp v35, v28, v28 row_half_mirror row_mask:0xf bank_mask:0x5
    v_add_f32_dpp v35, v30, v30 row_half_mirror row_mask:0xf bank_mask:0xa
    v_add_f32_dpp v32, v32, v32 quad_perm:[2,3,0,1] row_mask:0xf bank_mask:0xf
    v_add_f32_dpp v33, v33, v33 quad_perm:[2,3,0,1] row_mask:0xf bank_mask:0xf
    v_add_f32_dpp v34, v34, v34 quad_perm:[2,3,0,1] row_mask:0xf bank_mask:0xf
    v_add_f32_dpp v35, v35, v35 quad_perm:[2,3,0,1] row_mask:0xf bank_mask:0xf
    v_cndmask_b32 v32, v32, v33, s[86:87]
    v_cndmask_b32 v34, v34, v35, s[86:87]
    s_nop 0
    v_add_f32_dpp v32, v32, v32 quad_perm:[1,0,3,2] row_mask:0xf bank_mask:0xf
    v_add_f32_dpp v34, v34, v34 quad_perm:[1,0,3,2] row_mask:0xf bank_mask:0xf
    v_cndmask_b32 v55, v32, v34, s[88:89]
    s_waitcnt lgkmcnt(0)
    v_readfirstlane_b32 s85, v121
    v_readfirstlane_b32 s81, v122
    s_add_u32 s64, s64, 4
    s_nop 0
    s_sub_i32 s81, s81, s64
    s_mul_i32 s81, s81, 12
    s_add_i32 s81, s81, -16
    s_ashr_i32 s81, s81, 2
    s_add_i32 s85, s85, s81
    s_sub_u32 s80, s80, 1
    s_cmp_lg_u32 s80, 0
    s_cbranch_scc1 L_k1
    v_mov_b32 v40, v42
    v_mov_b32 v41, v43
    v_mov_b32 v42, v44
    v_mov_b32 v43, v45
    v_mov_b32 v44, v46
    v_mov_b32 v45, v47
    v_mov_b32 v46, v48
    v_mov_b32 v47, v49
    v_mov_b32 v48, v50
    v_mov_b32 v49, v51
    v_mov_b32 v50, v52
    v_mov_b32 v51, v53
    v_mov_b32 v52, v54
    v_mov_b32 v53, v55
    v_dot2_f32_bf16 v28, v128, v72, 0
    v_dot2_f32_bf16 v28, v129, v73, v28
    v_dot2_f32_bf16 v28, v130, v74, v28
    v_dot2_f32_bf16 v28, v131, v75, v28
    s_cmp_gt_i32 s85, 0
    s_cbranch_scc1 L_u61
    s_waitcnt vmcnt(4)
    s_cmp_ge_i32 s85, 0
    s_cbranch_scc1 L_u61
    s_waitcnt vmcnt(3)
L_u61:
    buffer_load_dwordx4 v[160:163], v7, s[56:59], s79 offen offset:0 nt
    v_dot2_f32_bf16 v29, v132, v72, 0
    v_dot2_f32_bf16 v29, v133, v73, v29
    v_dot2_f32_bf16 v29, v134, v74, v29
    v_dot2_f32_bf16 v29, v135, v75, v29
    s_waitcnt vmcnt(4)
    buffer_load_dwordx4 v[164:167], v7, s[56:59], s79 offen offset:1024 nt
    v_dot2_f32_bf16 v30, v136, v72, 0
    v_dot2_f32_bf16 v30, v137, v73, v30
    v_dot2_f32_bf16 v30, v138, v74, v30
    v_dot2_f32_bf16 v30, v139, v75, v30
    s_cmp_gt_i32 s85, 8
    s_cbranch_scc1 L_u62
    s_waitcnt vmcnt(4)
    s_cmp_ge_i32 s85, -8
    s_cbranch_scc1 L_u62
    s_waitcnt vmcnt(3)
L_u62:
    buffer_load_dwordx4 v[168:171], v7, s[56:59], s79 offen offset:2048 nt
    v_dot2_f32_bf16 v31, v140, v72, 0
    v_dot2_f32_bf16 v31, v141, v73, v31
    v_dot2_f32_bf16 v31, v142, v74, v31
    v_dot2_f32_bf16 v31, v143, v75, v31
    s_waitcnt vmcnt(4)
    buffer_load_dwordx4 v[172:175], v7, s[56:59], s79 offen offset:3072 nt
    s_add_u32 s79, s79, 4096
    v_add_f32_dpp v28, v28, v28 row_mirror row_mask:0xf bank_mask:0x3
    v_add_f32_dpp v28, v29, v29 row_mirror row_mask:0xf bank_mask:0xc
    v_add_f32_dpp v30, v30, v30 row_mirror row_mask:0xf bank_mask:0x3
    v_add_f32_dpp v30, v31, v31 row_mirror row_mask:0xf bank_mask:0xc
    s_nop 0
    v_add_f32_dpp v32, v28, v28 row_half_mirror row_mask:0xf bank_mask:0x5
    v_add_f32_dpp v32, v30, v30 row_half_mirror row_mask:0xf bank_mask:0xa
    v_dot2_f32_bf16 v28, v144, v72, 0
    v_dot2_f32_bf16 v28, v145, v73, v28
    v_dot2_f32_bf16 v28, v146, v74, v28
    v_dot2_f32_bf16 v28, v147, v75, v28
    s_cmp_gt_i32 s85, 4
    s_cbranch_scc1 L_u63
    s_waitcnt vmcnt(4)
    s_cmp_ge_i32 s85, -4
    s_cbranch_scc1 L_u63
    s_waitcnt vmcnt(3)
L_u63:
    buffer_load_dwordx4 v[176:179], v7, s[56:59], s79 offen offset:0 nt
    v_dot2_f32_bf16 v29, v148, v72, 0
    v_dot2_f32_bf16 v29, v149, v73, v29
    v_dot2_f32_bf16 v29, v150, v74, v29
    v_dot2_f32_bf16 v29, v151, v75, v29
    s_waitcnt vmcnt(4)
    buffer_load_dwordx4 v[180:183], v7, s[56:59], s79 offen offset:1024 nt
    v_dot2_f32_bf16 v30, v152, v72, 0
    v_dot2_f32_bf16 v30, v153, v73, v30
    v_dot2_f32_bf16 v30, v154, v74, v30
    v_dot2_f32_bf16 v30, v155, v75, v30
    s_waitcnt vmcnt(4)
    buffer_load_dwordx4 v[184:187], v7, s[56:59], s79 offen offset:2048 nt
    v_dot2_f32_bf16 v31, v156, v72, 0
    v_dot2_f32_bf16 v31, v157, v73, v31
    v_dot2_f32_bf16 v31, v158, v74, v31
    v_dot2_f32_bf16 v31, v159, v75, v31
    s_waitcnt vmcnt(4)
    buffer_load_dwordx4 v[188:191], v7, s[56:59], s79 offen offset:3072 nt
    s_add_u32 s79, s79, 28672
    v_add_f32_dpp v28, v28, v28 row_mirror row_mask:0xf bank_mask:0x3
    v_add_f32_dpp v28, v29, v29 row_mirror row_mask:0xf bank_mask:0xc
    v_add_f32_dpp v30, v30, v30 row_mirror row_mask:0xf bank_mask:0x3
    v_add_f32_dpp v30, v31, v31 row_mirror row_mask:0xf bank_mask:0xc
    s_nop 0
    v_add_f32_dpp v33, v28, v28 row_half_mirror row_mask:0xf bank_mask:0x5
    v_add_f32_dpp v33, v30, v30 row_half_mirror row_mask:0xf bank_mask:0xa
    v_dot2_f32_bf16 v28, v160, v72, 0
    v_dot2_f32_bf16 v28, v161, v73, v28
    v_dot2_f32_bf16 v28, v162, v74, v28
    v_dot2_f32_bf16 v28, v163, v75, v28
    s_cmp_gt_i32 s85, 2
    s_cbranch_scc1 L_u64
    s_waitcnt vmcnt(4)
    s_cmp_ge_i32 s85, -2
    s_cbranch_scc1 L_u64
    s_waitcnt vmcnt(3)
L_u64:
    buffer_load_dwordx4 v[192:195], v7, s[56:59], s79 offen offset:0 nt
    v_dot2_f32_bf16 v29, v164, v72, 0
    v_dot2_f32_bf16 v29, v165, v73, v29
    v_dot2_f32_bf16 v29, v166, v74, v29
    v_dot2_f32_bf16 v29, v167, v75, v29
    s_waitcnt vmcnt(4)
    buffer_load_dwordx4 v[196:199], v7, s[56:59], s79 offen offset:1024 nt
    v_dot2_f32_bf16 v30, v168, v72, 0
    v_dot2_f32_bf16 v30, v169, v73, v30
    v_dot2_f32_bf16 v30, v170, v74, v30
    v_dot2_f32_bf16 v30, v171, v75, v30
    s_cmp_gt_i32 s85, 10
    s_cbranch_scc1 L_u65
    s_waitcnt vmcnt(4)
    s_cmp_ge_i32 s85, -10
    s_cbranch_scc1 L_u65
    s_waitcnt vmcnt(3)
L_u65:
    buffer_load_dwordx4 v[200:203], v7, s[56:59], s79 offen offset:2048 nt
    v_dot2_f32_bf16 v31, v172, v72, 0
    v_dot2_f32_bf16 v31, v173, v73, v31
    v_dot2_f32_bf16 v31, v174, v74, v31
    v_dot2_f32_bf16 v31, v175, v75, v31
    s_waitcnt vmcnt(4)
    buffer_load_dwordx4 v[204:207], v7, s[56:59], s79 offen offset:3072 nt
    s_add_u32 s79, s79, 4096
    v_add_f32_dpp v28, v28, v28 row_mirror row_mask:0xf bank_mask:0x3
    v_add_f32_dpp v28, v29, v29 row_mirror row_mask:0xf bank_mask:0xc
    v_add_f32_dpp v30, v30, v30 row_mirror row_mask:0xf bank_mask:0x3
    v_add_f32_dpp v30, v31, v31 row_mirror row_mask:0xf bank_mask:0xc
    s_nop 0
    v_add_f32_dpp v34, v28, v28 row_half_mirror row_mask:0xf bank_mask:0x5
    v_add_f32_dpp v34, v30, v30 row_half_mirror row_mask:0xf bank_mask:0xa
    v_dot2_f32_bf16 v28, v176, v72, 0
    v_dot2_f32_bf16 v28, v177, v73, v28
    v_dot2_f32_bf16 v28, v178, v74, v28
    v_dot2_f32_bf16 v28, v179, v75, v28
    s_cmp_gt_i32 s85, 6
    s_cbranch_scc1 L_u66
    s_waitcnt vmcnt(4)
    s_cmp_ge_i32 s85, -6
    s_cbranch_scc1 L_u66
    s_waitcnt vmcnt(3)
L_u66:
    buffer_load_dwordx4 v[208:211], v7, s[56:59], s79 offen offset:0 nt
    v_dot2_f32_bf16 v29, v180, v72, 0
    v_dot2_f32_bf16 v29, v181, v73, v29
    v_dot2_f32_bf16 v29, v182, v74, v29
    v_dot2_f32_bf16 v29, v183, v75, v29
    s_waitcnt vmcnt(4)
    buffer_load_dwordx4 v[212:215], v7, s[56:59], s79 offen offset:1024 nt
    v_dot2_f32_bf16 v30, v184, v72, 0
    v_dot2_f32_bf16 v30, v185, v73, v30
    v_dot2_f32_bf16 v30, v186, v74, v30
    v_dot2_f32_bf16 v30, v187, v75, v30
    s_waitcnt vmcnt(4)
    buffer_load_dwordx4 v[216:219], v7, s[56:59], s79 offen offset:2048 nt
    v_dot2_f32_bf16 v31, v188, v72, 0
    v_dot2_f32_bf16 v31, v189, v73, v31
    v_dot2_f32_bf16 v31, v190, v74, v31
    v_dot2_f32_bf16 v31, v191, v75, v31
    s_waitcnt vmcnt(4)
    buffer_load_dwordx4 v[220:223], v7, s[56:59], s79 offen offset:3072 nt
    s_add_u32 s79, s79, 28672
    v_add_f32_dpp v28, v28, v28 row_mirror row_mask:0xf bank_mask:0x3
    v_add_f32_dpp v28, v29, v29 row_mirror row_mask:0xf bank_mask:0xc
    v_add_f32_dpp v30, v30, v30 row_mirror row_mask:0xf bank_mask:0x3
    v_add_f32_dpp v30, v31, v31 row_mirror row_mask:0xf bank_mask:0xc
    s_nop 0
    v_add_f32_dpp v35, v28, v28 row_half_mirror row_mask:0xf bank_mask:0x5
    v_add_f32_dpp v35, v30, v30 row_half_mirror row_mask:0xf bank_mask:0xa
    v_add_f32_dpp v32, v32, v32 quad_perm:[2,3,0,1] row_mask:0xf bank_mask:0xf
    v_add_f32_dpp v33, v33, v33 quad_perm:[2,3,0,1] row_mask:0xf bank_mask:0xf
    v_add_f32_dpp v34, v34, v34 quad_perm:[2,3,0,1] row_mask:0xf bank_mask:0xf
    v_add_f32_dpp v35, v35, v35 quad_perm:[2,3,0,1] row_mask:0xf bank_mask:0xf
    v_cndmask_b32 v32, v32, v33, s[86:87]
    v_cndmask_b32 v34, v34, v35, s[86:87]
    s_nop 0
    v_add_f32_dpp v32, v32, v32 quad_perm:[1,0,3,2] row_mask:0xf bank_mask:0xf
    v_add_f32_dpp v34, v34, v34 quad_perm:[1,0,3,2] row_mask:0xf bank_mask:0xf
    v_cndmask_b32 v54, v32, v34, s[88:89]
    v_dot2_f32_bf16 v28, v192, v72, 0
    v_dot2_f32_bf16 v28, v193, v73, v28
    v_dot2_f32_bf16 v28, v194, v74, v28
    v_dot2_f32_bf16 v28, v195, v75, v28
    s_cmp_gt_i32 s85, 1
    s_cbranch_scc1 L_u67
    s_waitcnt vmcnt(4)
    s_cmp_ge_i32 s85, -1
    s_cbranch_scc1 L_u67
    s_waitcnt vmcnt(3)
L_u67:
    buffer_load_dwordx4 v[224:227], v7, s[56:59], s79 offen offset:0 nt
    v_dot2_f32_bf16 v29, v196, v72, 0
    v_dot2_f32_bf16 v29, v197, v73, v29
    v_dot2_f32_bf16 v29, v198, v74, v29
    v_dot2_f32_bf16 v29, v199, v75, v29
    s_waitcnt vmcnt(4)
    buffer_load_dwordx4 v[228:231], v7, s[56:59], s79 offen offset:1024 nt
    v_dot2_f32_bf16 v30, v200, v72, 0
    v_dot2_f32_bf16 v30, v201, v73, v30
    v_dot2_f32_bf16 v30, v202, v74, v30
    v_dot2_f32_bf16 v30, v203, v75, v30
    s_cmp_gt_i32 s85, 9
    s_cbranch_scc1 L_u68
    s_waitcnt vmcnt(4)
    s_cmp_ge_i32 s85, -9
    s_cbranch_scc1 L_u68
    s_waitcnt vmcnt(3)
L_u68:
    buffer_load_dwordx4 v[232:235], v7, s[56:59], s79 offen offset:2048 nt
    s_mov_b64 exec, 1
    ds_add_rtn_u32 v122, v111, v120 offset:9152
    s_mov_b64 exec, -1
    v_dot2_f32_bf16 v31, v204, v72, 0
    v_dot2_f32_bf16 v31, v205, v73, v31
    v_dot2_f32_bf16 v31, v206, v74, v31
    v_dot2_f32_bf16 v31, v207, v75, v31
    s_waitcnt vmcnt(4)
    buffer_load_dwordx4 v[236:239], v7, s[56:59], s79 offen offset:3072 nt
    s_add_u32 s79, s79, 4096
    v_add_f32_dpp v28, v28, v28 row_mirror row_mask:0xf bank_mask:0x3
    v_add_f32_dpp v28, v29, v29 row_mirror row_mask:0xf bank_mask:0xc
    v_add_f32_dpp v30, v30, v30 row_mirror row_mask:0xf bank_mask:0x3
    v_add_f32_dpp v30, v31, v31 row_mirror row_mask:0xf bank_mask:0xc
    s_nop 0
    v_add_f32_dpp v32, v28, v28 row_half_mirror row_mask:0xf bank_mask:0x5
    v_add_f32_dpp v32, v30, v30 row_half_mirror row_mask:0xf bank_mask:0xa
    v_dot2_f32_bf16 v28, v208, v72, 0
    v_dot2_f32_bf16 v28, v209, v73, v28
    v_dot2_f32_bf16 v28, v210, v74, v28
    v_dot2_f32_bf16 v28, v211, v75, v28
    s_cmp_gt_i32 s85, 5
    s_cbranch_scc1 L_u69
    s_waitcnt vmcnt(4)
    s_cmp_ge_i32 s85, -5
    s_cbranch_scc1 L_u69
    s_waitcnt vmcnt(3)
L_u69:
    buffer_load_dwordx4 v[240:243], v7, s[56:59], s79 offen offset:0 nt
    v_dot2_f32_bf16 v29, v212, v72, 0
    v_dot2_f32_bf16 v29, v213, v73, v29
    v_dot2_f32_bf16 v29, v214, v74, v29
    v_dot2_f32_bf16 v29, v215, v75, v29
    s_waitcnt vmcnt(4)
    buffer_load_dwordx4 v[244:247], v7, s[56:59], s79 offen offset:1024 nt
    v_dot2_f32_bf16 v30, v216, v72, 0
    v_dot2_f32_bf16 v30, v217, v73, v30
    v_dot2_f32_bf16 v30, v218, v74, v30
    v_dot2_f32_bf16 v30, v219, v75, v30
    s_waitcnt vmcnt(4)
    buffer_load_dwordx4 v[248:251], v7, s[56:59], s79 offen offset:2048 nt
    v_dot2_f32_bf16 v31, v220, v72, 0
    v_dot2_f32_bf16 v31, v221, v73, v31
    v_dot2_f32_bf16 v31, v222, v74, v31
    v_dot2_f32_bf16 v31, v223, v75, v31
    s_waitcnt vmcnt(4)
    buffer_load_dwordx4 v[252:255], v7, s[56:59], s79 offen offset:3072 nt
    s_add_u32 s79, s79, 28672
    v_add_f32_dpp v28, v28, v28 row_mirror row_mask:0xf bank_mask:0x3
    v_add_f32_dpp v28, v29, v29 row_mirror row_mask:0xf bank_mask:0xc
    v_add_f32_dpp v30, v30, v30 row_mirror row_mask:0xf bank_mask:0x3
    v_add_f32_dpp v30, v31, v31 row_mirror row_mask:0xf bank_mask:0xc
    s_nop 0
    v_add_f32_dpp v33, v28, v28 row_half_mirror row_mask:0xf bank_mask:0x5
    v_add_f32_dpp v33, v30, v30 row_half_mirror row_mask:0xf bank_mask:0xa
    v_dot2_f32_bf16 v28, v224, v72, 0
    v_dot2_f32_bf16 v28, v225, v73, v28
    v_dot2_f32_bf16 v28, v226, v74, v28
    v_dot2_f32_bf16 v28, v227, v75, v28
    s_mov_b32 s79, s93
    s_cmp_gt_i32 s85, 3
    s_cbranch_scc1 L_u70
    s_waitcnt vmcnt(4)
    s_cmp_ge_i32 s85, -3
    s_cbranch_scc1 L_u70
    s_waitcnt vmcnt(3)
L_u70:
    buffer_load_dwordx4 v[128:131], v7, s[60:63], s79 offen offset:0 nt
    v_dot2_f32_bf16 v29, v228, v72, 0
    v_dot2_f32_bf16 v29, v229, v73, v29
    v_dot2_f32_bf16 v29, v230, v74, v29
    v_dot2_f32_bf16 v29, v231, v75, v29
    s_waitcnt vmcnt(4)
    buffer_load_dwordx4 v[132:135], v7, s[60:63], s79 offen offset:1024 nt
    v_dot2_f32_bf16 v30, v232, v72, 0
    v_dot2_f32_bf16 v30, v233, v73, v30
    v_dot2_f32_bf16 v30, v234, v74, v30
    v_dot2_f32_bf16 v30, v235, v75, v30
    s_cmp_gt_i32 s85, 11
    s_cbranch_scc1 L_u71
    s_waitcnt vmcnt(4)
    s_cmp_ge_i32 s85, -11
    s_cbranch_scc1 L_u71
    s_waitcnt vmcnt(3)
L_u71:
    buffer_load_dwordx4 v[136:139], v7, s[60:63], s79 offen offset:2048 nt
    v_dot2_f32_bf16 v31, v236, v72, 0
    v_dot2_f32_bf16 v31, v237, v73, v31
    v_dot2_f32_bf16 v31, v238, v74, v31
    v_dot2_f32_bf16 v31, v239, v75, v31
    s_waitcnt vmcnt(4)
    buffer_load_dwordx4 v[140:143], v7, s[60:63], s79 offen offset:3072 nt
    s_add_u32 s79, s79, 4096
    v_add_f32_dpp v28, v28, v28 row_mirror row_mask:0xf bank_mask:0x3
    v_add_f32_dpp v28, v29, v29 row_mirror row_mask:0xf bank_mask:0xc
    v_add_f32_dpp v30, v30, v30 row_mirror row_mask:0xf bank_mask:0x3
    v_add_f32_dpp v30, v31, v31 row_mirror row_mask:0xf bank_mask:0xc
    s_nop 0
    v_add_f32_dpp v34, v28, v28 row_half_mirror row_mask:0xf bank_mask:0x5
    v_add_f32_dpp v34, v30, v30 row_half_mirror row_mask:0xf bank_mask:0xa
    v_dot2_f32_bf16 v28, v240, v72, 0
    v_dot2_f32_bf16 v28, v241, v73, v28
    v_dot2_f32_bf16 v28, v242, v74, v28
    v_dot2_f32_bf16 v28, v243, v75, v28
    s_cmp_gt_i32 s85, 7
    s_cbranch_scc1 L_u72
    s_waitcnt vmcnt(4)
    s_cmp_ge_i32 s85, -7
    s_cbranch_scc1 L_u72
    s_waitcnt vmcnt(3)
L_u72:
    buffer_load_dwordx4 v[144:147], v7, s[60:63], s79 offen offset:0 nt
    v_dot2_f32_bf16 v29, v244, v72, 0
    v_dot2_f32_bf16 v29, v245, v73, v29
    v_dot2_f32_bf16 v29, v246, v74, v29
    v_dot2_f32_bf16 v29, v247, v75, v29
    s_waitcnt vmcnt(4)
    buffer_load_dwordx4 v[148:151], v7, s[60:63], s79 offen offset:1024 nt
    ds_read_b32 v121, v111 offset:9156
    v_dot2_f32_bf16 v30, v248, v72, 0
    v_dot2_f32_bf16 v30, v249, v73, v30
    v_dot2_f32_bf16 v30, v250, v74, v30
    v_dot2_f32_bf16 v30, v251, v75, v30
    s_waitcnt vmcnt(4)
    buffer_load_dwordx4 v[152:155], v7, s[60:63], s79 offen offset:2048 nt
    v_dot2_f32_bf16 v31, v252, v72, 0
    v_dot2_f32_bf16 v31, v253, v73, v31
    v_dot2_f32_bf16 v31, v254, v74, v31
    v_dot2_f32_bf16 v31, v255, v75, v31
    s_waitcnt vmcnt(4)
    buffer_load_dwordx4 v[156:159], v7, s[60:63], s79 offen offset:3072 nt
    s_add_u32 s79, s79, 28672
    v_add_f32_dpp v28, v28, v28 row_mirror row_mask:0xf bank_mask:0x3
    v_add_f32_dpp v28, v29, v29 row_mirror row_mask:0xf bank_mask:0xc
    v_add_f32_dpp v30, v30, v30 row_mirror row_mask:0xf bank_mask:0x3
    v_add_f32_dpp v30, v31, v31 row_mirror row_mask:0xf bank_mask:0xc
    s_nop 0
    v_add_f32_dpp v35, v28, v28 row_half_mirror row_mask:0xf bank_mask:0x5
    v_add_f32_dpp v35, v30, v30 row_half_mirror row_mask:0xf bank_mask:0xa
    v_add_f32_dpp v32, v32, v32 quad_perm:[2,3,0,1] row_mask:0xf bank_mask:0xf
    v_add_f32_dpp v33, v33, v33 quad_perm:[2,3,0,1] row_mask:0xf bank_mask:0xf
    v_add_f32_dpp v34, v34, v34 quad_perm:[2,3,0,1] row_mask:0xf bank_mask:0xf
    v_add_f32_dpp v35, v35, v35 quad_perm:[2,3,0,1] row_mask:0xf bank_mask:0xf
    v_cndmask_b32 v32, v32, v33, s[86:87]
    v_cndmask_b32 v34, v34, v35, s[86:87]
    s_nop 0
    v_add_f32_dpp v32, v32, v32 quad_perm:[1,0,3,2] row_mask:0xf bank_mask:0xf
    v_add_f32_dpp v34, v34, v34 quad_perm:[1,0,3,2] row_mask:0xf bank_mask:0xf
    v_cndmask_b32 v55, v32, v34, s[88:89]
    s_waitcnt lgkmcnt(0)
    v_readfirstlane_b32 s85, v121
    v_readfirstlane_b32 s81, v122
    s_add_u32 s64, s64, 4
    s_nop 0
    s_sub_i32 s81, s81, s64
    s_mul_i32 s81, s81, 12
    s_add_i32 s81, s81, -16
    s_ashr_i32 s81, s81, 2
    s_add_i32 s85, s85, s81
    v_max3_f32 v37, v40, v41, v42
    v_max3_f32 v37, v37, v43, v44
    v_max3_f32 v37, v37, v45, v46
    v_max3_f32 v37, v37, v47, v48
    v_max3_f32 v37, v37, v49, v50
    v_max3_f32 v37, v37, v51, v52
    v_max3_f32 v37, v37, v53, v54
    v_max_f32 v37, v37, v55
    s_nop 1
    v_max_f32_dpp v37, v37, v37 row_mirror row_mask:0xf bank_mask:0xf
    s_nop 1
    v_max_f32_dpp v37, v37, v37 row_half_mirror row_mask:0xf bank_mask:0xf
    s_nop 1
    v_max_f32_dpp v37, v37, v37 quad_perm:[2,3,0,1] row_mask:0xf bank_mask:0xf
    s_nop 1
    v_max_f32_dpp v37, v37, v37 quad_perm:[1,0,3,2] row_mask:0xf bank_mask:0xf
    s_nop 1
    v_max_f32_dpp v37, v37, v37 row_bcast:15 row_mask:0xa bank_mask:0xf
    s_nop 1
    v_max_f32_dpp v37, v37, v37 row_bcast:31 row_mask:0xc bank_mask:0xf
    s_nop 0
    v_readlane_b32 s92, v37, 63
    v_mov_b32 v36, s83
    s_nop 0
    v_mul_f32 v36, s92, v36
    v_fma_f32 v40, v40, s83, -v36
    v_fma_f32 v41, v41, s83, -v36
    v_fma_f32 v42, v42, s83, -v36
    v_fma_f32 v43, v43, s83, -v36
    v_fma_f32 v44, v44, s83, -v36
    v_fma_f32 v45, v45, s83, -v36
    v_fma_f32 v46, v46, s83, -v36
    v_fma_f32 v47, v47, s83, -v36
    v_fma_f32 v48, v48, s83, -v36
    v_fma_f32 v49, v49, s83, -v36
    v_fma_f32 v50, v50, s83, -v36
    v_fma_f32 v51, v51, s83, -v36
    v_fma_f32 v52, v52, s83, -v36
    v_fma_f32 v53, v53, s83, -v36
    v_fma_f32 v54, v54, s83, -v36
    v_fma_f32 v55, v55, s83, -v36
    v_exp_f32 v40, v40
    v_exp_f32 v41, v41
    v_exp_f32 v42, v42
    v_exp_f32 v43, v43
    v_exp_f32 v44, v44
    v_exp_f32 v45, v45
    v_exp_f32 v46, v46
    v_exp_f32 v47, v47
    v_exp_f32 v48, v48
    v_exp_f32 v49, v49
    v_exp_f32 v50, v50
    v_exp_f32 v51, v51
    v_exp_f32 v52, v52
    v_exp_f32 v53, v53
    v_exp_f32 v54, v54
    v_exp_f32 v55, v55
    v_mov_b32 v12, 0
    v_mov_b32 v13, 0
    v_mov_b32 v14, 0
    v_mov_b32 v15, 0
    v_add_f32 v24, v40, v41
    v_add_f32 v24, v24, v42
    v_add_f32 v24, v24, v43
    v_add_f32 v24, v24, v44
    v_add_f32 v24, v24, v45
    v_add_f32 v24, v24, v46
    v_add_f32 v24, v24, v47
    v_add_f32 v24, v24, v48
    v_add_f32 v24, v24, v49
    v_add_f32 v24, v24, v50
    v_add_f32 v24, v24, v51
    v_add_f32 v24, v24, v52
    v_add_f32 v24, v24, v53
    v_add_f32 v24, v24, v54
    v_add_f32 v24, v24, v55
    v_cvt_pk_bf16_f32 v40, v40, v40
    v_cvt_pk_bf16_f32 v41, v41, v41
    v_cvt_pk_bf16_f32 v42, v42, v42
    v_cvt_pk_bf16_f32 v43, v43, v43
    v_cvt_pk_bf16_f32 v44, v44, v44
    v_cvt_pk_bf16_f32 v45, v45, v45
    v_cvt_pk_bf16_f32 v46, v46, v46
    v_cvt_pk_bf16_f32 v47, v47, v47
    v_cvt_pk_bf16_f32 v48, v48, v48
    v_cvt_pk_bf16_f32 v49, v49, v49
    v_cvt_pk_bf16_f32 v50, v50, v50
    v_cvt_pk_bf16_f32 v51, v51, v51
    v_cvt_pk_bf16_f32 v52, v52, v52
    v_cvt_pk_bf16_f32 v53, v53, v53
    v_cvt_pk_bf16_f32 v54, v54, v54
    v_cvt_pk_bf16_f32 v55, v55, v55
    s_nop 1
    v_add_f32_dpp v24, v24, v24 row_mirror row_mask:0xf bank_mask:0xf
    s_nop 1
    v_add_f32_dpp v24, v24, v24 row_half_mirror row_mask:0xf bank_mask:0xf
    s_nop 1
    v_add_f32_dpp v24, v24, v24 quad_perm:[2,3,0,1] row_mask:0xf bank_mask:0xf
    s_nop 1
    v_add_f32_dpp v24, v24, v24 quad_perm:[1,0,3,2] row_mask:0xf bank_mask:0xf
    s_nop 1
    v_add_f32_dpp v24, v24, v24 row_bcast:15 row_mask:0xa bank_mask:0xf
    s_nop 1
    v_add_f32_dpp v24, v24, v24 row_bcast:31 row_mask:0xc bank_mask:0xf
    s_nop 0
    v_readlane_b32 s94, v24, 63
    v_lshlrev_b32 v4, 5, v2
    v_lshl_add_u32 v4, v3, 4, v4
    s_lshl_b32 s81, s3, 9
    v_add_u32 v4, s81, v4
    s_lshl_b32 s81, s3, 3
    v_mov_b32 v5, s81
    v_mov_b32 v28, s92
    v_mov_b32 v29, s94
    s_mov_b32 s80, 7
L_v1:
    v_and_b32_dpp v16, v40, v8 row_newbcast:0 row_mask:0xf bank_mask:0xf
    v_and_b32_dpp v17, v40, v9 row_newbcast:0 row_mask:0xf bank_mask:0xf
    v_and_b32_dpp v18, v40, v10 row_newbcast:0 row_mask:0xf bank_mask:0xf
    v_and_b32_dpp v19, v40, v11 row_newbcast:0 row_mask:0xf bank_mask:0xf
    v_and_b32_dpp v20, v40, v8 row_newbcast:8 row_mask:0xf bank_mask:0xf
    v_and_b32_dpp v21, v40, v9 row_newbcast:8 row_mask:0xf bank_mask:0xf
    v_and_b32_dpp v22, v40, v10 row_newbcast:8 row_mask:0xf bank_mask:0xf
    v_and_b32_dpp v23, v40, v11 row_newbcast:8 row_mask:0xf bank_mask:0xf
    v_mfma_f32_16x16x32_bf16 v[12:15], v[16:19], v[128:131], v[12:15]
    s_cmp_gt_i32 s85, 0
    s_cbranch_scc1 L_u73
    s_waitcnt vmcnt(4)
    s_cmp_ge_i32 s85, 0
    s_cbranch_scc1 L_u73
    s_waitcnt vmcnt(3)
L_u73:
    buffer_load_dwordx4 v[160:163], v7, s[60:63], s79 offen offset:0 nt
    v_and_b32_dpp v16, v40, v8 row_newbcast:4 row_mask:0xf bank_mask:0xf
    v_and_b32_dpp v17, v40, v9 row_newbcast:4 row_mask:0xf bank_mask:0xf
    v_and_b32_dpp v18, v40, v10 row_newbcast:4 row_mask:0xf bank_mask:0xf
    v_and_b32_dpp v19, v40, v11 row_newbcast:4 row_mask:0xf bank_mask:0xf
    v_mfma_f32_16x16x32_bf16 v[12:15], v[20:23], v[132:135], v[12:15]
    s_waitcnt vmcnt(4)
    buffer_load_dwordx4 v[164:167], v7, s[60:63], s79 offen offset:1024 nt
    v_and_b32_dpp v20, v40, v8 row_newbcast:12 row_mask:0xf bank_mask:0xf
    v_and_b32_dpp v21, v40, v9 row_newbcast:12 row_mask:0xf bank_mask:0xf
    v_and_b32_dpp v22, v40, v10 row_newbcast:12 row_mask:0xf bank_mask:0xf
    v_and_b32_dpp v23, v40, v11 row_newbcast:12 row_mask:0xf bank_mask:0xf
    v_mfma_f32_16x16x32_bf16 v[12:15], v[16:19], v[136:139], v[12:15]
    s_cmp_gt_i32 s85, 8
    s_cbranch_scc1 L_u74
    s_waitcnt vmcnt(4)
    s_cmp_ge_i32 s85, -8
    s_cbranch_scc1 L_u74
    s_waitcnt vmcnt(3)
L_u74:
    buffer_load_dwordx4 v[168:171], v7, s[60:63], s79 offen offset:2048 nt
    v_and_b32_dpp v16, v40, v8 row_newbcast:2 row_mask:0xf bank_mask:0xf
    v_and_b32_dpp v17, v40, v9 row_newbcast:2 row_mask:0xf bank_mask:0xf
    v_and_b32_dpp v18, v40, v10 row_newbcast:2 row_mask:0xf bank_mask:0xf
    v_and_b32_dpp v19, v40, v11 row_newbcast:2 row_mask:0xf bank_mask:0xf
    v_mfma_f32_16x16x32_bf16 v[12:15], v[20:23], v[140:143], v[12:15]
    s_waitcnt vmcnt(4)
    buffer_load_dwordx4 v[172:175], v7, s[60:63], s79 offen offset:3072 nt
    s_add_u32 s79, s79, 4096
    v_and_b32_dpp v20, v40, v8 row_newbcast:10 row_mask:0xf bank_mask:0xf
    v_and_b32_dpp v21, v40, v9 row_newbcast:10 row_mask:0xf bank_mask:0xf
    v_and_b32_dpp v22, v40, v10 row_newbcast:10 row_mask:0xf bank_mask:0xf
    v_and_b32_dpp v23, v40, v11 row_newbcast:10 row_mask:0xf bank_mask:0xf
    v_mfma_f32_16x16x32_bf16 v[12:15], v[16:19], v[144:147], v[12:15]
    s_cmp_gt_i32 s85, 4
    s_cbranch_scc1 L_u75
    s_waitcnt vmcnt(4)
    s_cmp_ge_i32 s85, -4
    s_cbranch_scc1 L_u75
    s_waitcnt vmcnt(3)
L_u75:
    buffer_load_dwordx4 v[176:179], v7, s[60:63], s79 offen offset:0 nt
    v_and_b32_dpp v16, v40, v8 row_newbcast:6 row_mask:0xf bank_mask:0xf
    v_and_b32_dpp v17, v40, v9 row_newbcast:6 row_mask:0xf bank_mask:0xf
    v_and_b32_dpp v18, v40, v10 row_newbcast:6 row_mask:0xf bank_mask:0xf
    v_and_b32_dpp v19, v40, v11 row_newbcast:6 row_mask:0xf bank_mask:0xf
    v_mfma_f32_16x16x32_bf16 v[12:15], v[20:23], v[148:151], v[12:15]
    s_waitcnt vmcnt(4)
    buffer_load_dwordx4 v[180:183], v7, s[60:63], s79 offen offset:1024 nt
    v_and_b32_dpp v20, v40, v8 row_newbcast:14 row_mask:0xf bank_mask:0xf
    v_and_b32_dpp v21, v40, v9 row_newbcast:14 row_mask:0xf bank_mask:0xf
    v_and_b32_dpp v22, v40, v10 row_newbcast:14 row_mask:0xf bank_mask:0xf
    v_and_b32_dpp v23, v40, v11 row_newbcast:14 row_mask:0xf bank_mask:0xf
    v_mfma_f32_16x16x32_bf16 v[12:15], v[16:19], v[152:155], v[12:15]
    s_waitcnt vmcnt(4)
    buffer_load_dwordx4 v[184:187], v7, s[60:63], s79 offen offset:2048 nt
    v_and_b32_dpp v16, v40, v8 row_newbcast:1 row_mask:0xf bank_mask:0xf
    v_and_b32_dpp v17, v40, v9 row_newbcast:1 row_mask:0xf bank_mask:0xf
    v_and_b32_dpp v18, v40, v10 row_newbcast:1 row_mask:0xf bank_mask:0xf
    v_and_b32_dpp v19, v40, v11 row_newbcast:1 row_mask:0xf bank_mask:0xf
    v_mfma_f32_16x16x32_bf16 v[12:15], v[20:23], v[156:159], v[12:15]
    s_waitcnt vmcnt(4)
    buffer_load_dwordx4 v[188:191], v7, s[60:63], s79 offen offset:3072 nt
    s_add_u32 s79, s79, 28672
    v_and_b32_dpp v20, v40, v8 row_newbcast:9 row_mask:0xf bank_mask:0xf
    v_and_b32_dpp v21, v40, v9 row_newbcast:9 row_mask:0xf bank_mask:0xf
    v_and_b32_dpp v22, v40, v10 row_newbcast:9 row_mask:0xf bank_mask:0xf
    v_and_b32_dpp v23, v40, v11 row_newbcast:9 row_mask:0xf bank_mask:0xf
    v_mfma_f32_16x16x32_bf16 v[12:15], v[16:19], v[160:163], v[12:15]
    s_cmp_gt_i32 s85, 2
    s_cbranch_scc1 L_u76
    s_waitcnt vmcnt(4)
    s_cmp_ge_i32 s85, -2
    s_cbranch_scc1 L_u76
    s_waitcnt vmcnt(3)
L_u76:
    buffer_load_dwordx4 v[192:195], v7, s[60:63], s79 offen offset:0 nt
    v_and_b32_dpp v16, v40, v8 row_newbcast:5 row_mask:0xf bank_mask:0xf
    v_and_b32_dpp v17, v40, v9 row_newbcast:5 row_mask:0xf bank_mask:0xf
    v_and_b32_dpp v18, v40, v10 row_newbcast:5 row_mask:0xf bank_mask:0xf
    v_and_b32_dpp v19, v40, v11 row_newbcast:5 row_mask:0xf bank_mask:0xf
    v_mfma_f32_16x16x32_bf16 v[12:15], v[20:23], v[164:167], v[12:15]
    s_waitcnt vmcnt(4)
    buffer_load_dwordx4 v[196:199], v7, s[60:63], s79 offen offset:1024 nt
    v_and_b32_dpp v20, v40, v8 row_newbcast:13 row_mask:0xf bank_mask:0xf
    v_and_b32_dpp v21, v40, v9 row_newbcast:13 row_mask:0xf bank_mask:0xf
    v_and_b32_dpp v22, v40, v10 row_newbcast:13 row_mask:0xf bank_mask:0xf
    v_and_b32_dpp v23, v40, v11 row_newbcast:13 row_mask:0xf bank_mask:0xf
    v_mfma_f32_16x16x32_bf16 v[12:15], v[16:19], v[168:171], v[12:15]
    s_cmp_gt_i32 s85, 10
    s_cbranch_scc1 L_u77
    s_waitcnt vmcnt(4)
    s_cmp_ge_i32 s85, -10
    s_cbranch_scc1 L_u77
    s_waitcnt vmcnt(3)
L_u77:
    buffer_load_dwordx4 v[200:203], v7, s[60:63], s79 offen offset:2048 nt
    v_and_b32_dpp v16, v40, v8 row_newbcast:3 row_mask:0xf bank_mask:0xf
    v_and_b32_dpp v17, v40, v9 row_newbcast:3 row_mask:0xf bank_mask:0xf
    v_and_b32_dpp v18, v40, v10 row_newbcast:3 row_mask:0xf bank_mask:0xf
    v_and_b32_dpp v19, v40, v11 row_newbcast:3 row_mask:0xf bank_mask:0xf
    v_mfma_f32_16x16x32_bf16 v[12:15], v[20:23], v[172:175], v[12:15]
    s_waitcnt vmcnt(4)
    buffer_load_dwordx4 v[204:207], v7, s[60:63], s79 offen offset:3072 nt
    s_add_u32 s79, s79, 4096
    v_and_b32_dpp v20, v40, v8 row_newbcast:11 row_mask:0xf bank_mask:0xf
    v_and_b32_dpp v21, v40, v9 row_newbcast:11 row_mask:0xf bank_mask:0xf
    v_and_b32_dpp v22, v40, v10 row_newbcast:11 row_mask:0xf bank_mask:0xf
    v_and_b32_dpp v23, v40, v11 row_newbcast:11 row_mask:0xf bank_mask:0xf
    v_mfma_f32_16x16x32_bf16 v[12:15], v[16:19], v[176:179], v[12:15]
    s_cmp_gt_i32 s85, 6
    s_cbranch_scc1 L_u78
    s_waitcnt vmcnt(4)
    s_cmp_ge_i32 s85, -6
    s_cbranch_scc1 L_u78
    s_waitcnt vmcnt(3)
L_u78:
    buffer_load_dwordx4 v[208:211], v7, s[60:63], s79 offen offset:0 nt
    v_and_b32_dpp v16, v40, v8 row_newbcast:7 row_mask:0xf bank_mask:0xf
    v_and_b32_dpp v17, v40, v9 row_newbcast:7 row_mask:0xf bank_mask:0xf
    v_and_b32_dpp v18, v40, v10 row_newbcast:7 row_mask:0xf bank_mask:0xf
    v_and_b32_dpp v19, v40, v11 row_newbcast:7 row_mask:0xf bank_mask:0xf
    v_mfma_f32_16x16x32_bf16 v[12:15], v[20:23], v[180:183], v[12:15]
    s_waitcnt vmcnt(4)
    buffer_load_dwordx4 v[212:215], v7, s[60:63], s79 offen offset:1024 nt
    v_and_b32_dpp v20, v40, v8 row_newbcast:15 row_mask:0xf bank_mask:0xf
    v_and_b32_dpp v21, v40, v9 row_newbcast:15 row_mask:0xf bank_mask:0xf
    v_and_b32_dpp v22, v40, v10 row_newbcast:15 row_mask:0xf bank_mask:0xf
    v_and_b32_dpp v23, v40, v11 row_newbcast:15 row_mask:0xf bank_mask:0xf
    v_mfma_f32_16x16x32_bf16 v[12:15], v[16:19], v[184:187], v[12:15]
    s_waitcnt vmcnt(4)
    buffer_load_dwordx4 v[216:219], v7, s[60:63], s79 offen offset:2048 nt
    v_and_b32_dpp v16, v41, v8 row_newbcast:0 row_mask:0xf bank_mask:0xf
    v_and_b32_dpp v17, v41, v9 row_newbcast:0 row_mask:0xf bank_mask:0xf
    v_and_b32_dpp v18, v41, v10 row_newbcast:0 row_mask:0xf bank_mask:0xf
    v_and_b32_dpp v19, v41, v11 row_newbcast:0 row_mask:0xf bank_mask:0xf
    v_mfma_f32_16x16x32_bf16 v[12:15], v[20:23], v[188:191], v[12:15]
    s_waitcnt vmcnt(4)
    buffer_load_dwordx4 v[220:223], v7, s[60:63], s79 offen offset:3072 nt
    s_add_u32 s79, s79, 28672
    v_and_b32_dpp v20, v41, v8 row_newbcast:8 row_mask:0xf bank_mask:0xf
    v_and_b32_dpp v21, v41, v9 row_newbcast:8 row_mask:0xf bank_mask:0xf
    v_and_b32_dpp v22, v41, v10 row_newbcast:8 row_mask:0xf bank_mask:0xf
    v_and_b32_dpp v23, v41, v11 row_newbcast:8 row_mask:0xf bank_mask:0xf
    v_mfma_f32_16x16x32_bf16 v[12:15], v[16:19], v[192:195], v[12:15]
    s_cmp_gt_i32 s85, 1
    s_cbranch_scc1 L_u79
    s_waitcnt vmcnt(4)
    s_cmp_ge_i32 s85, -1
    s_cbranch_scc1 L_u79
    s_waitcnt vmcnt(3)
L_u79:
    buffer_load_dwordx4 v[224:227], v7, s[60:63], s79 offen offset:0 nt
    v_and_b32_dpp v16, v41, v8 row_newbcast:4 row_mask:0xf bank_mask:0xf
    v_and_b32_dpp v17, v41, v9 row_newbcast:4 row_mask:0xf bank_mask:0xf
    v_and_b32_dpp v18, v41, v10 row_newbcast:4 row_mask:0xf bank_mask:0xf
    v_and_b32_dpp v19, v41, v11 row_newbcast:4 row_mask:0xf bank_mask:0xf
    v_mfma_f32_16x16x32_bf16 v[12:15], v[20:23], v[196:199], v[12:15]
    s_waitcnt vmcnt(4)
    buffer_load_dwordx4 v[228:231], v7, s[60:63], s79 offen offset:1024 nt
    v_and_b32_dpp v20, v41, v8 row_newbcast:12 row_mask:0xf bank_mask:0xf
    v_and_b32_dpp v21, v41, v9 row_newbcast:12 row_mask:0xf bank_mask:0xf
    v_and_b32_dpp v22, v41, v10 row_newbcast:12 row_mask:0xf bank_mask:0xf
    v_and_b32_dpp v23, v41, v11 row_newbcast:12 row_mask:0xf bank_mask:0xf
    v_mfma_f32_16x16x32_bf16 v[12:15], v[16:19], v[200:203], v[12:15]
    s_cmp_gt_i32 s85, 9
    s_cbranch_scc1 L_u80
    s_waitcnt vmcnt(4)
    s_cmp_ge_i32 s85, -9
    s_cbranch_scc1 L_u80
    s_waitcnt vmcnt(3)
L_u80:
    buffer_load_dwordx4 v[232:235], v7, s[60:63], s79 offen offset:2048 nt
    s_mov_b64 exec, 1
    ds_add_rtn_u32 v122, v111, v120 offset:9152
    s_mov_b64 exec, -1
    v_and_b32_dpp v16, v41, v8 row_newbcast:2 row_mask:0xf bank_mask:0xf
    v_and_b32_dpp v17, v41, v9 row_newbcast:2 row_mask:0xf bank_mask:0xf
    v_and_b32_dpp v18, v41, v10 row_newbcast:2 row_mask:0xf bank_mask:0xf
    v_and_b32_dpp v19, v41, v11 row_newbcast:2 row_mask:0xf bank_mask:0xf
    v_mfma_f32_16x16x32_bf16 v[12:15], v[20:23], v[204:207], v[12:15]
    s_waitcnt vmcnt(4)
    buffer_load_dwordx4 v[236:239], v7, s[60:63], s79 offen offset:3072 nt
    s_add_u32 s79, s79, 4096
    v_and_b32_dpp v20, v41, v8 row_newbcast:10 row_mask:0xf bank_mask:0xf
    v_and_b32_dpp v21, v41, v9 row_newbcast:10 row_mask:0xf bank_mask:0xf
    v_and_b32_dpp v22, v41, v10 row_newbcast:10 row_mask:0xf bank_mask:0xf
    v_and_b32_dpp v23, v41, v11 row_newbcast:10 row_mask:0xf bank_mask:0xf
    v_mfma_f32_16x16x32_bf16 v[12:15], v[16:19], v[208:211], v[12:15]
    s_cmp_gt_i32 s85, 5
    s_cbranch_scc1 L_u81
    s_waitcnt vmcnt(4)
    s_cmp_ge_i32 s85, -5
    s_cbranch_scc1 L_u81
    s_waitcnt vmcnt(3)
L_u81:
    buffer_load_dwordx4 v[240:243], v7, s[60:63], s79 offen offset:0 nt
    v_and_b32_dpp v16, v41, v8 row_newbcast:6 row_mask:0xf bank_mask:0xf
    v_and_b32_dpp v17, v41, v9 row_newbcast:6 row_mask:0xf bank_mask:0xf
    v_and_b32_dpp v18, v41, v10 row_newbcast:6 row_mask:0xf bank_mask:0xf
    v_and_b32_dpp v19, v41, v11 row_newbcast:6 row_mask:0xf bank_mask:0xf
    v_mfma_f32_16x16x32_bf16 v[12:15], v[20:23], v[212:215], v[12:15]
    s_waitcnt vmcnt(4)
    buffer_load_dwordx4 v[244:247], v7, s[60:63], s79 offen offset:1024 nt
    v_and_b32_dpp v20, v41, v8 row_newbcast:14 row_mask:0xf bank_mask:0xf
    v_and_b32_dpp v21, v41, v9 row_newbcast:14 row_mask:0xf bank_mask:0xf
    v_and_b32_dpp v22, v41, v10 row_newbcast:14 row_mask:0xf bank_mask:0xf
    v_and_b32_dpp v23, v41, v11 row_newbcast:14 row_mask:0xf bank_mask:0xf
    v_mfma_f32_16x16x32_bf16 v[12:15], v[16:19], v[216:219], v[12:15]
    s_waitcnt vmcnt(4)
    buffer_load_dwordx4 v[248:251], v7, s[60:63], s79 offen offset:2048 nt
    v_and_b32_dpp v16, v41, v8 row_newbcast:1 row_mask:0xf bank_mask:0xf
    v_and_b32_dpp v17, v41, v9 row_newbcast:1 row_mask:0xf bank_mask:0xf
    v_and_b32_dpp v18, v41, v10 row_newbcast:1 row_mask:0xf bank_mask:0xf
    v_and_b32_dpp v19, v41, v11 row_newbcast:1 row_mask:0xf bank_mask:0xf
    v_mfma_f32_16x16x32_bf16 v[12:15], v[20:23], v[220:223], v[12:15]
    s_waitcnt vmcnt(4)
    buffer_load_dwordx4 v[252:255], v7, s[60:63], s79 offen offset:3072 nt
    s_add_u32 s79, s79, 28672
    v_and_b32_dpp v20, v41, v8 row_newbcast:9 row_mask:0xf bank_mask:0xf
    v_and_b32_dpp v21, v41, v9 row_newbcast:9 row_mask:0xf bank_mask:0xf
    v_and_b32_dpp v22, v41, v10 row_newbcast:9 row_mask:0xf bank_mask:0xf
    v_and_b32_dpp v23, v41, v11 row_newbcast:9 row_mask:0xf bank_mask:0xf
    v_mfma_f32_16x16x32_bf16 v[12:15], v[16:19], v[224:227], v[12:15]
    s_cmp_gt_i32 s85, 3
    s_cbranch_scc1 L_u82
    s_waitcnt vmcnt(4)
    s_cmp_ge_i32 s85, -3
    s_cbranch_scc1 L_u82
    s_waitcnt vmcnt(3)
L_u82:
    buffer_load_dwordx4 v[128:131], v7, s[60:63], s79 offen offset:0 nt
    v_and_b32_dpp v16, v41, v8 row_newbcast:5 row_mask:0xf bank_mask:0xf
    v_and_b32_dpp v17, v41, v9 row_newbcast:5 row_mask:0xf bank_mask:0xf
    v_and_b32_dpp v18, v41, v10 row_newbcast:5 row_mask:0xf bank_mask:0xf
    v_and_b32_dpp v19, v41, v11 row_newbcast:5 row_mask:0xf bank_mask:0xf
    v_mfma_f32_16x16x32_bf16 v[12:15], v[20:23], v[228:231], v[12:15]
    s_waitcnt vmcnt(4)
    buffer_load_dwordx4 v[132:135], v7, s[60:63], s79 offen offset:1024 nt
    v_and_b32_dpp v20, v41, v8 row_newbcast:13 row_mask:0xf bank_mask:0xf
    v_and_b32_dpp v21, v41, v9 row_newbcast:13 row_mask:0xf bank_mask:0xf
    v_and_b32_dpp v22, v41, v10 row_newbcast:13 row_mask:0xf bank_mask:0xf
    v_and_b32_dpp v23, v41, v11 row_newbcast:13 row_mask:0xf bank_mask:0xf
    v_mfma_f32_16x16x32_bf16 v[12:15], v[16:19], v[232:235], v[12:15]
    s_cmp_gt_i32 s85, 11
    s_cbranch_scc1 L_u83
    s_waitcnt vmcnt(4)
    s_cmp_ge_i32 s85, -11
    s_cbranch_scc1 L_u83
    s_waitcnt vmcnt(3)
L_u83:
    buffer_load_dwordx4 v[136:139], v7, s[60:63], s79 offen offset:2048 nt
    v_and_b32_dpp v16, v41, v8 row_newbcast:3 row_mask:0xf bank_mask:0xf
    v_and_b32_dpp v17, v41, v9 row_newbcast:3 row_mask:0xf bank_mask:0xf
    v_and_b32_dpp v18, v41, v10 row_newbcast:3 row_mask:0xf bank_mask:0xf
    v_and_b32_dpp v19, v41, v11 row_newbcast:3 row_mask:0xf bank_mask:0xf
    v_mfma_f32_16x16x32_bf16 v[12:15], v[20:23], v[236:239], v[12:15]
    s_waitcnt vmcnt(4)
    buffer_load_dwordx4 v[140:143], v7, s[60:63], s79 offen offset:3072 nt
    s_add_u32 s79, s79, 4096
    v_and_b32_dpp v20, v41, v8 row_newbcast:11 row_mask:0xf bank_mask:0xf
    v_and_b32_dpp v21, v41, v9 row_newbcast:11 row_mask:0xf bank_mask:0xf
    v_and_b32_dpp v22, v41, v10 row_newbcast:11 row_mask:0xf bank_mask:0xf
    v_and_b32_dpp v23, v41, v11 row_newbcast:11 row_mask:0xf bank_mask:0xf
    v_mfma_f32_16x16x32_bf16 v[12:15], v[16:19], v[240:243], v[12:15]
    s_cmp_gt_i32 s85, 7
    s_cbranch_scc1 L_u84
    s_waitcnt vmcnt(4)
    s_cmp_ge_i32 s85, -7
    s_cbranch_scc1 L_u84
    s_waitcnt vmcnt(3)
L_u84:
    buffer_load_dwordx4 v[144:147], v7, s[60:63], s79 offen offset:0 nt
    v_and_b32_dpp v16, v41, v8 row_newbcast:7 row_mask:0xf bank_mask:0xf
    v_and_b32_dpp v17, v41, v9 row_newbcast:7 row_mask:0xf bank_mask:0xf
    v_and_b32_dpp v18, v41, v10 row_newbcast:7 row_mask:0xf bank_mask:0xf
    v_and_b32_dpp v19, v41, v11 row_newbcast:7 row_mask:0xf bank_mask:0xf
    v_mfma_f32_16x16x32_bf16 v[12:15], v[20:23], v[244:247], v[12:15]
    s_waitcnt vmcnt(4)
    buffer_load_dwordx4 v[148:151], v7, s[60:63], s79 offen offset:1024 nt
    ds_read_b32 v121, v111 offset:9156
    v_and_b32_dpp v20, v41, v8 row_newbcast:15 row_mask:0xf bank_mask:0xf
    v_and_b32_dpp v21, v41, v9 row_newbcast:15 row_mask:0xf bank_mask:0xf
    v_and_b32_dpp v22, v41, v10 row_newbcast:15 row_mask:0xf bank_mask:0xf
    v_and_b32_dpp v23, v41, v11 row_newbcast:15 row_mask:0xf bank_mask:0xf
    v_mfma_f32_16x16x32_bf16 v[12:15], v[16:19], v[248:251], v[12:15]
    s_waitcnt vmcnt(4)
    buffer_load_dwordx4 v[152:155], v7, s[60:63], s79 offen offset:2048 nt
    s_nop 1
    v_mfma_f32_16x16x32_bf16 v[12:15], v[20:23], v[252:255], v[12:15]
    s_waitcnt vmcnt(4)
    buffer_load_dwordx4 v[156:159], v7, s[60:63], s79 offen offset:3072 nt
    s_add_u32 s79, s79, 28672
    v_mov_b32 v40, v42
    v_mov_b32 v41, v43
    v_mov_b32 v42, v44
    v_mov_b32 v43, v45
    v_mov_b32 v44, v46
    v_mov_b32 v45, v47
    v_mov_b32 v46, v48
    v_mov_b32 v47, v49
    v_mov_b32 v48, v50
    v_mov_b32 v49, v51
    v_mov_b32 v50, v52
    v_mov_b32 v51, v53
    v_mov_b32 v52, v54
    v_mov_b32 v53, v55
    s_waitcnt lgkmcnt(0)
    v_readfirstlane_b32 s85, v121
    v_readfirstlane_b32 s81, v122
    s_add_u32 s64, s64, 4
    s_nop 0
    s_sub_i32 s81, s81, s64
    s_mul_i32 s81, s81, 12
    s_add_i32 s81, s81, -16
    s_ashr_i32 s81, s81, 2
    s_add_i32 s85, s85, s81
    s_sub_u32 s80, s80, 1
    s_cmp_lg_u32 s80, 0
    s_cbranch_scc1 L_v1
    v_and_b32_dpp v16, v40, v8 row_newbcast:0 row_mask:0xf bank_mask:0xf
    v_and_b32_dpp v17, v40, v9 row_newbcast:0 row_mask:0xf bank_mask:0xf
    v_and_b32_dpp v18, v40, v10 row_newbcast:0 row_mask:0xf bank_mask:0xf
    v_and_b32_dpp v19, v40, v11 row_newbcast:0 row_mask:0xf bank_mask:0xf
    v_and_b32_dpp v20, v40, v8 row_newbcast:8 row_mask:0xf bank_mask:0xf
    v_and_b32_dpp v21, v40, v9 row_newbcast:8 row_mask:0xf bank_mask:0xf
    v_and_b32_dpp v22, v40, v10 row_newbcast:8 row_mask:0xf bank_mask:0xf
    v_and_b32_dpp v23, v40, v11 row_newbcast:8 row_mask:0xf bank_mask:0xf
    v_mfma_f32_16x16x32_bf16 v[12:15], v[16:19], v[128:131], v[12:15]
    s_cmp_gt_i32 s85, 0
    s_cbranch_scc1 L_u85
    s_waitcnt vmcnt(4)
    s_cmp_ge_i32 s85, 0
    s_cbranch_scc1 L_u85
    s_waitcnt vmcnt(3)
L_u85:
    buffer_load_dwordx4 v[160:163], v7, s[60:63], s79 offen offset:0 nt
    v_and_b32_dpp v16, v40, v8 row_newbcast:4 row_mask:0xf bank_mask:0xf
    v_and_b32_dpp v17, v40, v9 row_newbcast:4 row_mask:0xf bank_mask:0xf
    v_and_b32_dpp v18, v40, v10 row_newbcast:4 row_mask:0xf bank_mask:0xf
    v_and_b32_dpp v19, v40, v11 row_newbcast:4 row_mask:0xf bank_mask:0xf
    v_mfma_f32_16x16x32_bf16 v[12:15], v[20:23], v[132:135], v[12:15]
    s_waitcnt vmcnt(4)
    buffer_load_dwordx4 v[164:167], v7, s[60:63], s79 offen offset:1024 nt
    v_and_b32_dpp v20, v40, v8 row_newbcast:12 row_mask:0xf bank_mask:0xf
    v_and_b32_dpp v21, v40, v9 row_newbcast:12 row_mask:0xf bank_mask:0xf
    v_and_b32_dpp v22, v40, v10 row_newbcast:12 row_mask:0xf bank_mask:0xf
    v_and_b32_dpp v23, v40, v11 row_newbcast:12 row_mask:0xf bank_mask:0xf
    v_mfma_f32_16x16x32_bf16 v[12:15], v[16:19], v[136:139], v[12:15]
    s_cmp_gt_i32 s85, 8
    s_cbranch_scc1 L_u86
    s_waitcnt vmcnt(4)
    s_cmp_ge_i32 s85, -8
    s_cbranch_scc1 L_u86
    s_waitcnt vmcnt(3)
L_u86:
    buffer_load_dwordx4 v[168:171], v7, s[60:63], s79 offen offset:2048 nt
    v_and_b32_dpp v16, v40, v8 row_newbcast:2 row_mask:0xf bank_mask:0xf
    v_and_b32_dpp v17, v40, v9 row_newbcast:2 row_mask:0xf bank_mask:0xf
    v_and_b32_dpp v18, v40, v10 row_newbcast:2 row_mask:0xf bank_mask:0xf
    v_and_b32_dpp v19, v40, v11 row_newbcast:2 row_mask:0xf bank_mask:0xf
    v_mfma_f32_16x16x32_bf16 v[12:15], v[20:23], v[140:143], v[12:15]
    s_waitcnt vmcnt(4)
    buffer_load_dwordx4 v[172:175], v7, s[60:63], s79 offen offset:3072 nt
    s_add_u32 s79, s79, 4096
    v_and_b32_dpp v20, v40, v8 row_newbcast:10 row_mask:0xf bank_mask:0xf
    v_and_b32_dpp v21, v40, v9 row_newbcast:10 row_mask:0xf bank_mask:0xf
    v_and_b32_dpp v22, v40, v10 row_newbcast:10 row_mask:0xf bank_mask:0xf
    v_and_b32_dpp v23, v40, v11 row_newbcast:10 row_mask:0xf bank_mask:0xf
    v_mfma_f32_16x16x32_bf16 v[12:15], v[16:19], v[144:147], v[12:15]
    s_cmp_gt_i32 s85, 4
    s_cbranch_scc1 L_u87
    s_waitcnt vmcnt(4)
    s_cmp_ge_i32 s85, -4
    s_cbranch_scc1 L_u87
    s_waitcnt vmcnt(3)
L_u87:
    buffer_load_dwordx4 v[176:179], v7, s[60:63], s79 offen offset:0 nt
    v_and_b32_dpp v16, v40, v8 row_newbcast:6 row_mask:0xf bank_mask:0xf
    v_and_b32_dpp v17, v40, v9 row_newbcast:6 row_mask:0xf bank_mask:0xf
    v_and_b32_dpp v18, v40, v10 row_newbcast:6 row_mask:0xf bank_mask:0xf
    v_and_b32_dpp v19, v40, v11 row_newbcast:6 row_mask:0xf bank_mask:0xf
    v_mfma_f32_16x16x32_bf16 v[12:15], v[20:23], v[148:151], v[12:15]
    s_waitcnt vmcnt(4)
    buffer_load_dwordx4 v[180:183], v7, s[60:63], s79 offen offset:1024 nt
    v_and_b32_dpp v20, v40, v8 row_newbcast:14 row_mask:0xf bank_mask:0xf
    v_and_b32_dpp v21, v40, v9 row_newbcast:14 row_mask:0xf bank_mask:0xf
    v_and_b32_dpp v22, v40, v10 row_newbcast:14 row_mask:0xf bank_mask:0xf
    v_and_b32_dpp v23, v40, v11 row_newbcast:14 row_mask:0xf bank_mask:0xf
    v_mfma_f32_16x16x32_bf16 v[12:15], v[16:19], v[152:155], v[12:15]
    s_waitcnt vmcnt(4)
    buffer_load_dwordx4 v[184:187], v7, s[60:63], s79 offen offset:2048 nt
    v_and_b32_dpp v16, v40, v8 row_newbcast:1 row_mask:0xf bank_mask:0xf
    v_and_b32_dpp v17, v40, v9 row_newbcast:1 row_mask:0xf bank_mask:0xf
    v_and_b32_dpp v18, v40, v10 row_newbcast:1 row_mask:0xf bank_mask:0xf
    v_and_b32_dpp v19, v40, v11 row_newbcast:1 row_mask:0xf bank_mask:0xf
    v_mfma_f32_16x16x32_bf16 v[12:15], v[20:23], v[156:159], v[12:15]
    s_waitcnt vmcnt(4)
    buffer_load_dwordx4 v[188:191], v7, s[60:63], s79 offen offset:3072 nt
    s_add_u32 s79, s79, 28672
    v_and_b32_dpp v20, v40, v8 row_newbcast:9 row_mask:0xf bank_mask:0xf
    v_and_b32_dpp v21, v40, v9 row_newbcast:9 row_mask:0xf bank_mask:0xf
    v_and_b32_dpp v22, v40, v10 row_newbcast:9 row_mask:0xf bank_mask:0xf
    v_and_b32_dpp v23, v40, v11 row_newbcast:9 row_mask:0xf bank_mask:0xf
    v_mfma_f32_16x16x32_bf16 v[12:15], v[16:19], v[160:163], v[12:15]
    s_cmp_gt_i32 s85, 2
    s_cbranch_scc1 L_u88
    s_waitcnt vmcnt(4)
    s_cmp_ge_i32 s85, -2
    s_cbranch_scc1 L_u88
    s_waitcnt vmcnt(3)
L_u88:
    buffer_load_dwordx4 v[192:195], v7, s[60:63], s79 offen offset:0 nt
    v_and_b32_dpp v16, v40, v8 row_newbcast:5 row_mask:0xf bank_mask:0xf
    v_and_b32_dpp v17, v40, v9 row_newbcast:5 row_mask:0xf bank_mask:0xf
    v_and_b32_dpp v18, v40, v10 row_newbcast:5 row_mask:0xf bank_mask:0xf
    v_and_b32_dpp v19, v40, v11 row_newbcast:5 row_mask:0xf bank_mask:0xf
    v_mfma_f32_16x16x32_bf16 v[12:15], v[20:23], v[164:167], v[12:15]
    s_waitcnt vmcnt(4)
    buffer_load_dwordx4 v[196:199], v7, s[60:63], s79 offen offset:1024 nt
    v_and_b32_dpp v20, v40, v8 row_newbcast:13 row_mask:0xf bank_mask:0xf
    v_and_b32_dpp v21, v40, v9 row_newbcast:13 row_mask:0xf bank_mask:0xf
    v_and_b32_dpp v22, v40, v10 row_newbcast:13 row_mask:0xf bank_mask:0xf
    v_and_b32_dpp v23, v40, v11 row_newbcast:13 row_mask:0xf bank_mask:0xf
    v_mfma_f32_16x16x32_bf16 v[12:15], v[16:19], v[168:171], v[12:15]
    s_cmp_gt_i32 s85, 10
    s_cbranch_scc1 L_u89
    s_waitcnt vmcnt(4)
    s_cmp_ge_i32 s85, -10
    s_cbranch_scc1 L_u89
    s_waitcnt vmcnt(3)
L_u89:
    buffer_load_dwordx4 v[200:203], v7, s[60:63], s79 offen offset:2048 nt
    v_and_b32_dpp v16, v40, v8 row_newbcast:3 row_mask:0xf bank_mask:0xf
    v_and_b32_dpp v17, v40, v9 row_newbcast:3 row_mask:0xf bank_mask:0xf
    v_and_b32_dpp v18, v40, v10 row_newbcast:3 row_mask:0xf bank_mask:0xf
    v_and_b32_dpp v19, v40, v11 row_newbcast:3 row_mask:0xf bank_mask:0xf
    v_mfma_f32_16x16x32_bf16 v[12:15], v[20:23], v[172:175], v[12:15]
    s_waitcnt vmcnt(4)
    buffer_load_dwordx4 v[204:207], v7, s[60:63], s79 offen offset:3072 nt
    s_add_u32 s79, s79, 4096
    v_and_b32_dpp v20, v40, v8 row_newbcast:11 row_mask:0xf bank_mask:0xf
    v_and_b32_dpp v21, v40, v9 row_newbcast:11 row_mask:0xf bank_mask:0xf
    v_and_b32_dpp v22, v40, v10 row_newbcast:11 row_mask:0xf bank_mask:0xf
    v_and_b32_dpp v23, v40, v11 row_newbcast:11 row_mask:0xf bank_mask:0xf
    v_mfma_f32_16x16x32_bf16 v[12:15], v[16:19], v[176:179], v[12:15]
    s_cmp_gt_i32 s85, 6
    s_cbranch_scc1 L_u90
    s_waitcnt vmcnt(4)
    s_cmp_ge_i32 s85, -6
    s_cbranch_scc1 L_u90
    s_waitcnt vmcnt(3)
L_u90:
    buffer_load_dwordx4 v[208:211], v7, s[60:63], s79 offen offset:0 nt
    v_and_b32_dpp v16, v40, v8 row_newbcast:7 row_mask:0xf bank_mask:0xf
    v_and_b32_dpp v17, v40, v9 row_newbcast:7 row_mask:0xf bank_mask:0xf
    v_and_b32_dpp v18, v40, v10 row_newbcast:7 row_mask:0xf bank_mask:0xf
    v_and_b32_dpp v19, v40, v11 row_newbcast:7 row_mask:0xf bank_mask:0xf
    v_mfma_f32_16x16x32_bf16 v[12:15], v[20:23], v[180:183], v[12:15]
    s_waitcnt vmcnt(4)
    buffer_load_dwordx4 v[212:215], v7, s[60:63], s79 offen offset:1024 nt
    v_and_b32_dpp v20, v40, v8 row_newbcast:15 row_mask:0xf bank_mask:0xf
    v_and_b32_dpp v21, v40, v9 row_newbcast:15 row_mask:0xf bank_mask:0xf
    v_and_b32_dpp v22, v40, v10 row_newbcast:15 row_mask:0xf bank_mask:0xf
    v_and_b32_dpp v23, v40, v11 row_newbcast:15 row_mask:0xf bank_mask:0xf
    v_mfma_f32_16x16x32_bf16 v[12:15], v[16:19], v[184:187], v[12:15]
    s_waitcnt vmcnt(4)
    buffer_load_dwordx4 v[216:219], v7, s[60:63], s79 offen offset:2048 nt
    v_and_b32_dpp v16, v41, v8 row_newbcast:0 row_mask:0xf bank_mask:0xf
    v_and_b32_dpp v17, v41, v9 row_newbcast:0 row_mask:0xf bank_mask:0xf
    v_and_b32_dpp v18, v41, v10 row_newbcast:0 row_mask:0xf bank_mask:0xf
    v_and_b32_dpp v19, v41, v11 row_newbcast:0 row_mask:0xf bank_mask:0xf
    v_mfma_f32_16x16x32_bf16 v[12:15], v[20:23], v[188:191], v[12:15]
    s_waitcnt vmcnt(4)
    buffer_load_dwordx4 v[220:223], v7, s[60:63], s79 offen offset:3072 nt
    s_add_u32 s79, s79, 28672
    v_and_b32_dpp v20, v41, v8 row_newbcast:8 row_mask:0xf bank_mask:0xf
    v_and_b32_dpp v21, v41, v9 row_newbcast:8 row_mask:0xf bank_mask:0xf
    v_and_b32_dpp v22, v41, v10 row_newbcast:8 row_mask:0xf bank_mask:0xf
    v_and_b32_dpp v23, v41, v11 row_newbcast:8 row_mask:0xf bank_mask:0xf
    v_mfma_f32_16x16x32_bf16 v[12:15], v[16:19], v[192:195], v[12:15]
    s_cmp_gt_i32 s85, 1
    s_cbranch_scc1 L_u91
    s_waitcnt vmcnt(4)
    s_cmp_ge_i32 s85, -1
    s_cbranch_scc1 L_u91
    s_waitcnt vmcnt(3)
L_u91:
    buffer_load_dwordx4 v[224:227], v7, s[60:63], s79 offen offset:0 nt
    v_and_b32_dpp v16, v41, v8 row_newbcast:4 row_mask:0xf bank_mask:0xf
    v_and_b32_dpp v17, v41, v9 row_newbcast:4 row_mask:0xf bank_mask:0xf
    v_and_b32_dpp v18, v41, v10 row_newbcast:4 row_mask:0xf bank_mask:0xf
    v_and_b32_dpp v19, v41, v11 row_newbcast:4 row_mask:0xf bank_mask:0xf
    v_mfma_f32_16x16x32_bf16 v[12:15], v[20:23], v[196:199], v[12:15]
    s_waitcnt vmcnt(4)
    buffer_load_dwordx4 v[228:231], v7, s[60:63], s79 offen offset:1024 nt
    v_and_b32_dpp v20, v41, v8 row_newbcast:12 row_mask:0xf bank_mask:0xf
    v_and_b32_dpp v21, v41, v9 row_newbcast:12 row_mask:0xf bank_mask:0xf
    v_and_b32_dpp v22, v41, v10 row_newbcast:12 row_mask:0xf bank_mask:0xf
    v_and_b32_dpp v23, v41, v11 row_newbcast:12 row_mask:0xf bank_mask:0xf
    v_mfma_f32_16x16x32_bf16 v[12:15], v[16:19], v[200:203], v[12:15]
    s_cmp_gt_i32 s85, 9
    s_cbranch_scc1 L_u92
    s_waitcnt vmcnt(4)
    s_cmp_ge_i32 s85, -9
    s_cbranch_scc1 L_u92
    s_waitcnt vmcnt(3)
L_u92:
    buffer_load_dwordx4 v[232:235], v7, s[60:63], s79 offen offset:2048 nt
    v_and_b32_dpp v16, v41, v8 row_newbcast:2 row_mask:0xf bank_mask:0xf
    v_and_b32_dpp v17, v41, v9 row_newbcast:2 row_mask:0xf bank_mask:0xf
    v_and_b32_dpp v18, v41, v10 row_newbcast:2 row_mask:0xf bank_mask:0xf
    v_and_b32_dpp v19, v41, v11 row_newbcast:2 row_mask:0xf bank_mask:0xf
    v_mfma_f32_16x16x32_bf16 v[12:15], v[20:23], v[204:207], v[12:15]
    s_waitcnt vmcnt(4)
    buffer_load_dwordx4 v[236:239], v7, s[60:63], s79 offen offset:3072 nt
    s_add_u32 s79, s79, 4096
    v_and_b32_dpp v20, v41, v8 row_newbcast:10 row_mask:0xf bank_mask:0xf
    v_and_b32_dpp v21, v41, v9 row_newbcast:10 row_mask:0xf bank_mask:0xf
    v_and_b32_dpp v22, v41, v10 row_newbcast:10 row_mask:0xf bank_mask:0xf
    v_and_b32_dpp v23, v41, v11 row_newbcast:10 row_mask:0xf bank_mask:0xf
    v_mfma_f32_16x16x32_bf16 v[12:15], v[16:19], v[208:211], v[12:15]
    s_cmp_gt_i32 s85, 5
    s_cbranch_scc1 L_u93
    s_waitcnt vmcnt(4)
    s_cmp_ge_i32 s85, -5
    s_cbranch_scc1 L_u93
    s_waitcnt vmcnt(3)
L_u93:
    buffer_load_dwordx4 v[240:243], v7, s[60:63], s79 offen offset:0 nt
    s_mov_b64 exec, 1
    ds_add_u32 v111, v120 offset:9164
    s_mov_b64 exec, -1
    v_and_b32_dpp v16, v41, v8 row_newbcast:6 row_mask:0xf bank_mask:0xf
    v_and_b32_dpp v17, v41, v9 row_newbcast:6 row_mask:0xf bank_mask:0xf
    v_and_b32_dpp v18, v41, v10 row_newbcast:6 row_mask:0xf bank_mask:0xf
    v_and_b32_dpp v19, v41, v11 row_newbcast:6 row_mask:0xf bank_mask:0xf
    v_mfma_f32_16x16x32_bf16 v[12:15], v[20:23], v[212:215], v[12:15]
    s_waitcnt vmcnt(4)
    buffer_load_dwordx4 v[244:247], v7, s[60:63], s79 offen offset:1024 nt
    v_and_b32_dpp v20, v41, v8 row_newbcast:14 row_mask:0xf bank_mask:0xf
    v_and_b32_dpp v21, v41, v9 row_newbcast:14 row_mask:0xf bank_mask:0xf
    v_and_b32_dpp v22, v41, v10 row_newbcast:14 row_mask:0xf bank_mask:0xf
    v_and_b32_dpp v23, v41, v11 row_newbcast:14 row_mask:0xf bank_mask:0xf
    v_mfma_f32_16x16x32_bf16 v[12:15], v[16:19], v[216:219], v[12:15]
    s_waitcnt vmcnt(4)
    buffer_load_dwordx4 v[248:251], v7, s[60:63], s79 offen offset:2048 nt
    v_and_b32_dpp v16, v41, v8 row_newbcast:1 row_mask:0xf bank_mask:0xf
    v_and_b32_dpp v17, v41, v9 row_newbcast:1 row_mask:0xf bank_mask:0xf
    v_and_b32_dpp v18, v41, v10 row_newbcast:1 row_mask:0xf bank_mask:0xf
    v_and_b32_dpp v19, v41, v11 row_newbcast:1 row_mask:0xf bank_mask:0xf
    v_mfma_f32_16x16x32_bf16 v[12:15], v[20:23], v[220:223], v[12:15]
    s_waitcnt vmcnt(4)
    buffer_load_dwordx4 v[252:255], v7, s[60:63], s79 offen offset:3072 nt
    s_add_u32 s79, s79, 28672
    v_and_b32_dpp v20, v41, v8 row_newbcast:9 row_mask:0xf bank_mask:0xf
    v_and_b32_dpp v21, v41, v9 row_newbcast:9 row_mask:0xf bank_mask:0xf
    v_and_b32_dpp v22, v41, v10 row_newbcast:9 row_mask:0xf bank_mask:0xf
    v_and_b32_dpp v23, v41, v11 row_newbcast:9 row_mask:0xf bank_mask:0xf
    v_mfma_f32_16x16x32_bf16 v[12:15], v[16:19], v[224:227], v[12:15]
    v_and_b32_dpp v16, v41, v8 row_newbcast:5 row_mask:0xf bank_mask:0xf
    v_and_b32_dpp v17, v41, v9 row_newbcast:5 row_mask:0xf bank_mask:0xf
    v_and_b32_dpp v18, v41, v10 row_newbcast:5 row_mask:0xf bank_mask:0xf
    v_and_b32_dpp v19, v41, v11 row_newbcast:5 row_mask:0xf bank_mask:0xf
    v_mfma_f32_16x16x32_bf16 v[12:15], v[20:23], v[228:231], v[12:15]
    v_and_b32_dpp v20, v41, v8 row_newbcast:13 row_mask:0xf bank_mask:0xf
    v_and_b32_dpp v21, v41, v9 row_newbcast:13 row_mask:0xf bank_mask:0xf
    v_and_b32_dpp v22, v41, v10 row_newbcast:13 row_mask:0xf bank_mask:0xf
    v_and_b32_dpp v23, v41, v11 row_newbcast:13 row_mask:0xf bank_mask:0xf
    v_mfma_f32_16x16x32_bf16 v[12:15], v[16:19], v[232:235], v[12:15]
    v_and_b32_dpp v16, v41, v8 row_newbcast:3 row_mask:0xf bank_mask:0xf
    v_and_b32_dpp v17, v41, v9 row_newbcast:3 row_mask:0xf bank_mask:0xf
    v_and_b32_dpp v18, v41, v10 row_newbcast:3 row_mask:0xf bank_mask:0xf
    v_and_b32_dpp v19, v41, v11 row_newbcast:3 row_mask:0xf bank_mask:0xf
    s_waitcnt vmcnt(4)
    v_mfma_f32_16x16x32_bf16 v[12:15], v[20:23], v[236:239], v[12:15]
    v_and_b32_dpp v20, v41, v8 row_newbcast:11 row_mask:0xf bank_mask:0xf
    v_and_b32_dpp v21, v41, v9 row_newbcast:11 row_mask:0xf bank_mask:0xf
    v_and_b32_dpp v22, v41, v10 row_newbcast:11 row_mask:0xf bank_mask:0xf
    v_and_b32_dpp v23, v41, v11 row_newbcast:11 row_mask:0xf bank_mask:0xf
    s_waitcnt vmcnt(3)
    v_mfma_f32_16x16x32_bf16 v[12:15], v[16:19], v[240:243], v[12:15]
    v_and_b32_dpp v16, v41, v8 row_newbcast:7 row_mask:0xf bank_mask:0xf
    v_and_b32_dpp v17, v41, v9 row_newbcast:7 row_mask:0xf bank_mask:0xf
    v_and_b32_dpp v18, v41, v10 row_newbcast:7 row_mask:0xf bank_mask:0xf
    v_and_b32_dpp v19, v41, v11 row_newbcast:7 row_mask:0xf bank_mask:0xf
    s_waitcnt vmcnt(2)
    v_mfma_f32_16x16x32_bf16 v[12:15], v[20:23], v[244:247], v[12:15]
    v_and_b32_dpp v20, v41, v8 row_newbcast:15 row_mask:0xf bank_mask:0xf
    v_and_b32_dpp v21, v41, v9 row_newbcast:15 row_mask:0xf bank_mask:0xf
    v_and_b32_dpp v22, v41, v10 row_newbcast:15 row_mask:0xf bank_mask:0xf
    v_and_b32_dpp v23, v41, v11 row_newbcast:15 row_mask:0xf bank_mask:0xf
    s_waitcnt vmcnt(1)
    v_mfma_f32_16x16x32_bf16 v[12:15], v[16:19], v[248:251], v[12:15]
    s_nop 1
    s_waitcnt vmcnt(0)
    v_mfma_f32_16x16x32_bf16 v[12:15], v[20:23], v[252:255], v[12:15]
    v_mov_b32 v40, v42
    v_mov_b32 v41, v43
    v_mov_b32 v42, v44
    v_mov_b32 v43, v45
    v_mov_b32 v44, v46
    v_mov_b32 v45, v47
    v_mov_b32 v46, v48
    v_mov_b32 v47, v49
    v_mov_b32 v48, v50
    v_mov_b32 v49, v51
    v_mov_b32 v50, v52
    v_mov_b32 v51, v53
    v_mov_b32 v52, v54
    v_mov_b32 v53, v55
    s_mov_b32 exec_hi, 0
    ds_write_b128 v4, v[12:15] offset:2560
    s_mov_b32 exec_lo, 1
    ds_write_b64 v5, v[28:29] offset:4640
    s_mov_b64 exec, -1
    v_lshrrev_b32 v4, 7, v0
    v_lshlrev_b32 v5, 5, v4
    v_lshlrev_b32 v4, 11, v4
    v_and_b32 v36, 127, v0
    v_lshl_add_u32 v4, v36, 2, v4
    s_lshl_b32 s81, s77, 3
    s_add_u32 s81, s81, s78
    s_lshl_b32 s81, s81, 10
    s_add_u32 s80, s81, 0x400000
    s_waitcnt lgkmcnt(0)
    s_mov_b64 exec, 1
    ds_add_u32 v111, v120 offset:9160
    s_mov_b64 exec, -1
L_meet:
    ds_read_b32 v121, v111 offset:9160
    s_waitcnt lgkmcnt(0)
    v_cmp_gt_u32 vcc, 4, v121
    s_cbranch_vccnz L_meet
    ds_read_b128 v[24:27], v5 offset:4608
    ds_read_b128 v[28:31], v5 offset:4624
    ds_read_b32 v16, v4 offset:512
    ds_read_b32 v17, v4 offset:1024
    ds_read_b32 v18, v4 offset:1536
    ds_read_b32 v19, v4 offset:2048
    s_waitcnt lgkmcnt(4)
    v_max3_f32 v4, v24, v26, v28
    v_max_f32 v4, v4, v30
    v_mul_f32 v36, s83, v4
    v_fma_f32 v24, v24, s83, -v36
    v_fma_f32 v26, v26, s83, -v36
    v_fma_f32 v28, v28, s83, -v36
    v_fma_f32 v30, v30, s83, -v36
    v_exp_f32 v24, v24
    v_exp_f32 v26, v26
    v_exp_f32 v28, v28
    v_exp_f32 v30, v30
    s_nop 0
    v_mul_f32 v4, v24, v25
    v_fma_f32 v4, v26, v27, v4
    v_fma_f32 v4, v28, v29, v4
    v_fma_f32 v4, v30, v31, v4
    v_rcp_f32 v4, v4
    s_waitcnt lgkmcnt(0)
    v_mul_f32 v5, v24, v16
    v_fma_f32 v5, v26, v17, v5
    v_fma_f32 v5, v28, v18, v5
    v_fma_f32 v5, v30, v19, v5
    v_mul_f32 v5, v5, v4
    v_mov_b32 v21, s76
    v_lshlrev_b32 v36, 2, v0
    v_mov_b32_dpp v4, v5 quad_perm:[1,0,3,2] row_mask:0xf bank_mask:0xf
    v_cvt_pk_bf16_f32 v20, v5, v4
    s_mov_b32 exec_lo, 0x55555555
    s_mov_b32 exec_hi, 0x55555555
    buffer_store_dwordx2 v[20:21], v36, s[72:75], s80 offen sc1
    s_mov_b64 exec, -1
    v_and_b32 v4, 7, v1
    v_mul_u32_u24 v5, 272, v4
    v_lshl_add_u32 v5, v3, 4, v5
    v_bfe_u32 v36, v1, 3, 1
    v_lshlrev_b32 v4, 9, v4
    s_lshl_b32 s81, s78, 5
    s_add_u32 s81, s81, s77
    s_lshl_b32 s81, s81, 13
    s_lshl_b32 s82, s3, 7
    s_add_u32 s81, s81, s82
    s_add_u32 s82, s81, 4096
    v_lshl_add_u32 v4, v36, 6, v4
    v_lshl_add_u32 v4, v3, 4, v4
    v_mov_b32 v37, 0xff
    v_mov_b32 v36, s76
    s_barrier
    ds_read_b64_tr_b16 v[128:129], v38 offset:0
    ds_read_b64_tr_b16 v[130:131], v38 offset:1024
    ds_read_b64_tr_b16 v[132:133], v38 offset:8192
    ds_read_b64_tr_b16 v[134:135], v38 offset:9216
    ds_read_b64_tr_b16 v[136:137], v38 offset:16384
    ds_read_b64_tr_b16 v[138:139], v38 offset:17408
    ds_read_b64_tr_b16 v[140:141], v38 offset:24576
    ds_read_b64_tr_b16 v[142:143], v38 offset:25600
    ds_read_b64_tr_b16 v[144:145], v108 offset:0
    ds_read_b64_tr_b16 v[146:147], v108 offset:1024
    ds_read_b64_tr_b16 v[148:149], v108 offset:8192
    ds_read_b64_tr_b16 v[150:151], v108 offset:9216
    ds_read_b64_tr_b16 v[152:153], v108 offset:16384
    ds_read_b64_tr_b16 v[154:155], v108 offset:17408
    ds_read_b64_tr_b16 v[156:157], v108 offset:24576
    ds_read_b64_tr_b16 v[158:159], v108 offset:25600
    ds_read_b64_tr_b16 v[160:161], v38 offset:32768
    ds_read_b64_tr_b16 v[162:163], v38 offset:33792
    ds_read_b64_tr_b16 v[164:165], v38 offset:40960
    ds_read_b64_tr_b16 v[166:167], v38 offset:41984
    ds_read_b64_tr_b16 v[168:169], v38 offset:49152
    ds_read_b64_tr_b16 v[170:171], v38 offset:50176
    ds_read_b64_tr_b16 v[172:173], v38 offset:57344
    ds_read_b64_tr_b16 v[174:175], v38 offset:58368
    ds_read_b64_tr_b16 v[176:177], v108 offset:32768
    ds_read_b64_tr_b16 v[178:179], v108 offset:33792
    ds_read_b64_tr_b16 v[180:181], v108 offset:40960
    ds_read_b64_tr_b16 v[182:183], v108 offset:41984
    ds_read_b64_tr_b16 v[184:185], v108 offset:49152
    ds_read_b64_tr_b16 v[186:187], v108 offset:50176
    ds_read_b64_tr_b16 v[188:189], v108 offset:57344
    ds_read_b64_tr_b16 v[190:191], v108 offset:58368
    s_barrier
    ds_read_b128 v[192:195], v5 offset:4672
    ds_read_b128 v[196:199], v5 offset:4736
    ds_read_b128 v[200:203], v5 offset:4800
    ds_read_b128 v[204:207], v5 offset:4864
    ds_read_b128 v[208:211], v5 offset:6848
    ds_read_b128 v[212:215], v5 offset:6912
    ds_read_b128 v[216:219], v5 offset:6976
    ds_read_b128 v[220:223], v5 offset:7040
    s_waitcnt lgkmcnt(4)
    v_mfma_f32_16x16x32_bf16 v[224:227], v[128:131], v[192:195], 0
    v_mfma_f32_16x16x32_bf16 v[228:231], v[144:147], v[192:195], 0
    v_mfma_f32_16x16x32_bf16 v[224:227], v[132:135], v[196:199], v[224:227]
    v_mfma_f32_16x16x32_bf16 v[228:231], v[148:151], v[196:199], v[228:231]
    v_mfma_f32_16x16x32_bf16 v[224:227], v[136:139], v[200:203], v[224:227]
    v_mfma_f32_16x16x32_bf16 v[228:231], v[152:155], v[200:203], v[228:231]
    v_mfma_f32_16x16x32_bf16 v[224:227], v[140:143], v[204:207], v[224:227]
    v_mfma_f32_16x16x32_bf16 v[228:231], v[156:159], v[204:207], v[228:231]
    s_waitcnt lgkmcnt(0)
    v_mfma_f32_16x16x32_bf16 v[232:235], v[160:163], v[208:211], 0
    v_mfma_f32_16x16x32_bf16 v[236:239], v[176:179], v[208:211], 0
    v_mfma_f32_16x16x32_bf16 v[232:235], v[164:167], v[212:215], v[232:235]
    v_mfma_f32_16x16x32_bf16 v[236:239], v[180:183], v[212:215], v[236:239]
    v_mfma_f32_16x16x32_bf16 v[232:235], v[168:171], v[216:219], v[232:235]
    v_mfma_f32_16x16x32_bf16 v[236:239], v[184:187], v[216:219], v[236:239]
    v_mfma_f32_16x16x32_bf16 v[232:235], v[172:175], v[220:223], v[232:235]
    v_mfma_f32_16x16x32_bf16 v[236:239], v[188:191], v[220:223], v[236:239]
    s_nop 0
    v_cndmask_b32 v224, v224, v228, s[90:91]
    v_cndmask_b32 v225, v225, v229, s[90:91]
    v_cndmask_b32 v226, v226, v230, s[90:91]
    v_cndmask_b32 v227, v227, v231, s[90:91]
    v_bfi_b32 v224, v37, v36, v224
    v_bfi_b32 v225, v37, v36, v225
    v_bfi_b32 v226, v37, v36, v226
    v_bfi_b32 v227, v37, v36, v227
    buffer_store_dwordx4 v[224:227], v4, s[72:75], s81 offen sc1
    s_nop 0
    v_cndmask_b32 v232, v232, v236, s[90:91]
    v_cndmask_b32 v233, v233, v237, s[90:91]
    v_cndmask_b32 v234, v234, v238, s[90:91]
    v_cndmask_b32 v235, v235, v239, s[90:91]
    v_bfi_b32 v232, v37, v36, v232
    v_bfi_b32 v233, v37, v36, v233
    v_bfi_b32 v234, v37, v36, v234
    v_bfi_b32 v235, v37, v36, v235
    buffer_store_dwordx4 v[232:235], v4, s[72:75], s82 offen sc1
    s_waitcnt vmcnt(0)
    s_barrier
    s_endpgm
L_comm:
    s_setprio 3
    s_mov_b32 s64, s12
    s_mov_b32 s65, s13
    s_mov_b32 s66, 0x800000
    s_mov_b32 s67, 0x20000
    s_mov_b32 s68, s22
    s_mov_b32 s69, s23
    s_mov_b32 s70, 0x800000
    s_mov_b32 s71, 0x20000
    s_mov_b32 s32, s24
    s_mov_b32 s33, s25
    s_mov_b32 s34, 0x8000
    s_mov_b32 s35, 0x20000
    s_mov_b32 s93, s97
    v_add_u32 v6, 4096, v7
    s_lshl_b32 s81, s77, 16
    s_add_u32 s81, s81, 0x200000
    s_lshl_b32 s82, s78, 13
    s_add_u32 s79, s81, s82
    s_lshl_b32 s82, s78, 10
    s_add_u32 s97, s81, s82
    v_lshlrev_b32 v5, 3, v1
    v_mov_b32 v111, 0
    v_mov_b32 v16, 0
    v_mov_b32 v17, 0
    v_mov_b32 v18, 0
    v_mov_b32 v19, 0
    ds_write_b128 v111, v[16:19] offset:9152
    s_barrier
    s_waitcnt lgkmcnt(0)
    s_mul_i32 s76, s76, 0x19660d
    s_add_u32 s76, s76, 0x3c6ef35f
    s_and_b32 s84, s76, 0xff
    s_barrier
    ds_read_b128 v[16:19], v7 offset:9216
    ds_read_b128 v[20:23], v7 offset:10256
    ds_read_b128 v[24:27], v7 offset:11296
    ds_read_b128 v[28:31], v7 offset:12336
    ds_read_b128 v[32:35], v7 offset:13376
    ds_read_b128 v[36:39], v7 offset:14416
    ds_read_b128 v[40:43], v7 offset:15456
    ds_read_b128 v[44:47], v7 offset:16496
    s_waitcnt lgkmcnt(7)
    buffer_store_dwordx4 v[16:19], v7, s[72:75], s97 offen sc1
    s_add_u32 s97, s97, 8192
    s_waitcnt lgkmcnt(6)
    buffer_store_dwordx4 v[20:23], v7, s[72:75], s97 offen sc1
    s_add_u32 s97, s97, 8192
    s_waitcnt lgkmcnt(5)
    buffer_store_dwordx4 v[24:27], v7, s[72:75], s97 offen sc1
    s_add_u32 s97, s97, 8192
    s_waitcnt lgkmcnt(4)
    buffer_store_dwordx4 v[28:31], v7, s[72:75], s97 offen sc1
    s_add_u32 s97, s97, 8192
    s_waitcnt lgkmcnt(3)
    buffer_store_dwordx4 v[32:35], v7, s[72:75], s97 offen sc1
    s_add_u32 s97, s97, 8192
    s_waitcnt lgkmcnt(2)
    buffer_store_dwordx4 v[36:39], v7, s[72:75], s97 offen sc1
    s_add_u32 s97, s97, 8192
    s_waitcnt lgkmcnt(1)
    buffer_store_dwordx4 v[40:43], v7, s[72:75], s97 offen sc1
    s_add_u32 s97, s97, 8192
    s_waitcnt lgkmcnt(0)
    buffer_store_dwordx4 v[44:47], v7, s[72:75], s97 offen sc1
    s_add_u32 s97, s97, 8192
    s_waitcnt vmcnt(0)
    s_mov_b32 s80, 0x100000
L_pq:
    buffer_load_dwordx4 v[16:19], v7, s[72:75], s79 offen offset:0 sc1
    buffer_load_dwordx4 v[20:23], v7, s[72:75], s79 offen offset:1024 sc1
    buffer_load_dwordx4 v[24:27], v7, s[72:75], s79 offen offset:2048 sc1
    buffer_load_dwordx4 v[28:31], v7, s[72:75], s79 offen offset:3072 sc1
    buffer_load_dwordx4 v[32:35], v6, s[72:75], s79 offen offset:0 sc1
    buffer_load_dwordx4 v[36:39], v6, s[72:75], s79 offen offset:1024 sc1
    buffer_load_dwordx4 v[40:43], v6, s[72:75], s79 offen offset:2048 sc1
    buffer_load_dwordx4 v[44:47], v6, s[72:75], s79 offen offset:3072 sc1
    v_mov_b32 v80, 0
    s_waitcnt vmcnt(7)
    v_xor_b32 v16, s84, v16
    v_xor_b32 v17, s84, v17
    v_xor_b32 v18, s84, v18
    v_xor_b32 v19, s84, v19
    v_or3_b32 v80, v80, v16, v17
    v_or3_b32 v80, v80, v18, v19
    s_waitcnt vmcnt(6)
    v_xor_b32 v20, s84, v20
    v_xor_b32 v21, s84, v21
    v_xor_b32 v22, s84, v22
    v_xor_b32 v23, s84, v23
    v_or3_b32 v80, v80, v20, v21
    v_or3_b32 v80, v80, v22, v23
    s_waitcnt vmcnt(5)
    v_xor_b32 v24, s84, v24
    v_xor_b32 v25, s84, v25
    v_xor_b32 v26, s84, v26
    v_xor_b32 v27, s84, v27
    v_or3_b32 v80, v80, v24, v25
    v_or3_b32 v80, v80, v26, v27
    s_waitcnt vmcnt(4)
    v_xor_b32 v28, s84, v28
    v_xor_b32 v29, s84, v29
    v_xor_b32 v30, s84, v30
    v_xor_b32 v31, s84, v31
    v_or3_b32 v80, v80, v28, v29
    v_or3_b32 v80, v80, v30, v31
    s_waitcnt vmcnt(3)
    v_xor_b32 v32, s84, v32
    v_xor_b32 v33, s84, v33
    v_xor_b32 v34, s84, v34
    v_xor_b32 v35, s84, v35
    v_or3_b32 v80, v80, v32, v33
    v_or3_b32 v80, v80, v34, v35
    s_waitcnt vmcnt(2)
    v_xor_b32 v36, s84, v36
    v_xor_b32 v37, s84, v37
    v_xor_b32 v38, s84, v38
    v_xor_b32 v39, s84, v39
    v_or3_b32 v80, v80, v36, v37
    v_or3_b32 v80, v80, v38, v39
    s_waitcnt vmcnt(1)
    v_xor_b32 v40, s84, v40
    v_xor_b32 v41, s84, v41
    v_xor_b32 v42, s84, v42
    v_xor_b32 v43, s84, v43
    v_or3_b32 v80, v80, v40, v41
    v_or3_b32 v80, v80, v42, v43
    s_waitcnt vmcnt(0)
    v_xor_b32 v44, s84, v44
    v_xor_b32 v45, s84, v45
    v_xor_b32 v46, s84, v46
    v_xor_b32 v47, s84, v47
    v_or3_b32 v80, v80, v44, v45
    v_or3_b32 v80, v80, v46, v47
    v_and_b32 v80, 0xff, v80
    v_cmp_ne_u32 vcc, 0, v80
    s_cbranch_vccz L_pq_ok
    s_sleep 2
    s_sub_u32 s80, s80, 1
    s_cmp_lg_u32 s80, 0
    s_cbranch_scc1 L_pq
L_pq_ok:
    v_add_f32 v16, v16, v20
    v_add_f32 v24, v24, v28
    v_add_f32 v32, v32, v36
    v_add_f32 v40, v40, v44
    v_add_f32 v16, v16, v24
    v_add_f32 v32, v32, v40
    v_add_f32 v16, v16, v32
    v_add_f32 v17, v17, v21
    v_add_f32 v25, v25, v29
    v_add_f32 v33, v33, v37
    v_add_f32 v41, v41, v45
    v_add_f32 v17, v17, v25
    v_add_f32 v33, v33, v41
    v_add_f32 v17, v17, v33
    v_add_f32 v18, v18, v22
    v_add_f32 v26, v26, v30
    v_add_f32 v34, v34, v38
    v_add_f32 v42, v42, v46
    v_add_f32 v18, v18, v26
    v_add_f32 v34, v34, v42
    v_add_f32 v18, v18, v34
    v_add_f32 v19, v19, v23
    v_add_f32 v27, v27, v31
    v_add_f32 v35, v35, v39
    v_add_f32 v43, v43, v47
    v_add_f32 v19, v19, v27
    v_add_f32 v35, v35, v43
    v_add_f32 v19, v19, v35
    v_cvt_pk_bf16_f32 v16, v16, v17
    v_cvt_pk_bf16_f32 v17, v18, v19
    ds_write_b64 v5, v[16:17] offset:0
    s_waitcnt lgkmcnt(0)
    s_barrier
    v_lshlrev_b32 v39, 1, v3
    v_xor_b32 v39, v39, v2
    v_lshlrev_b32 v39, 4, v39
    v_lshl_add_u32 v39, v3, 11, v39
    v_xor_b32 v109, 128, v39
    s_lshl_b32 s81, s77, 18
    s_lshl_b32 s82, s78, 8
    s_add_u32 s96, s81, s82
    s_lshl_b32 s81, s77, 13
    s_add_u32 s79, s81, 0x400000
    v_lshrrev_b32 v4, 5, v1
    v_mul_u32_u24 v4, 2176, v4
    v_and_b32 v5, 31, v1
    v_lshl_add_u32 v4, v5, 3, v4
    v_add_u32 v4, 4672, v4
    v_add_u32 v5, 1088, v4
    s_mov_b32 s95, 17664
    s_getreg_b32 s81, hwreg(HW_REG_XCC_ID)
    s_and_b32 s81, s81, 15
    s_bitcmp1_b32 s81, 0
    s_cselect_b32 s83, -16, 16
    s_mul_i32 s81, s81, 4352
    s_add_u32 s38, s81, 0x510000
    s_getreg_b32 s82, hwreg(HW_REG_HW_ID, 13, 2)
    s_getreg_b32 s81, hwreg(HW_REG_HW_ID, 8, 4)
    s_lshl_b32 s82, s82, 6
    s_lshl_b32 s81, s81, 2
    s_add_u32 s82, s82, s81
    s_add_u32 s36, s38, s82
    v_lshlrev_b32 v82, 2, v1
    v_mul_u32_u24 v83, 4352, v1
    s_add_u32 s40, s38, 0x10000
    s_mov_b32 s41, 0x520000
    s_add_u32 s42, s38, 252
    s_lshr_b32 s43, s2, 3
    s_and_b32 s81, s43, 1
    s_cmp_eq_u32 s81, 0
    s_cselect_b32 s43, s43, 0
    s_cmp_le_u32 s43, 26
    s_cselect_b32 s43, s43, 0
    s_and_b32 s39, s76, 0xffffff00
    s_mov_b32 s94, 1
L_ctl:
    s_lshl_b32 s81, s94, 2
    s_sub_u32 s81, s81, 2
L_ctla:
    s_sleep 1
    ds_read_b32 v16, v111 offset:9152
    s_waitcnt lgkmcnt(0)
    v_cmp_gt_u32 vcc, s81, v16
    s_cbranch_vccnz L_ctla
    s_or_b32 s92, s39, s94
    s_cmp_lg_u32 s94, s43
    s_cbranch_scc1 L_ctlb
    s_mov_b64 exec, 0xff
    buffer_load_dword v19, v83, s[72:75], s41 offen sc1
    v_mov_b32 v17, s92
    s_mov_b64 exec, 1
    buffer_store_dword v17, v111, s[72:75], s40 offen sc1
    s_mov_b64 exec, -1
L_ctlb:
    v_mov_b32 v17, s92
    s_mov_b64 exec, 1
    buffer_store_dword v17, v111, s[72:75], s36 offen
    s_mov_b64 exec, -1
    buffer_load_dword v18, v82, s[72:75], s38 offen sc1
    s_waitcnt vmcnt(0)
    v_xor_b32 v18, s39, v18
    s_cmp_lg_u32 s94, s43
    s_cbranch_scc1 L_ctly
    v_xor_b32 v19, s39, v19
    v_subrev_u32 v19, s94, v19
    s_mov_b64 exec, 0xff
    v_cmp_gt_u32 vcc, 64, v19
    s_nop 1
    s_bcnt1_i32_b64 s85, vcc
    s_mul_i32 s85, s85, 8
    s_min_u32 s85, s85, 63
    s_or_b32 s85, s85, 128
    s_or_b32 s85, s85, s39
    v_mov_b32 v17, s85
    s_mov_b64 exec, 1
    buffer_store_dword v17, v111, s[72:75], s42 offen
    s_mov_b64 exec, -1
L_ctly:
    s_nop 0
    v_readlane_b32 s92, v18, 63
    v_subrev_u32 v18, s94, v18
    v_cmp_gt_u32 vcc, 64, v18
    s_nop 1
    s_bcnt1_i32_b64 s85, vcc
    s_sub_i32 s85, s85, 16
    s_mul_i32 s85, s85, 4
    s_sub_u32 s92, s92, 128
    s_cmp_lt_u32 s92, 64
    s_cselect_b32 s92, s92, 8
    s_sub_i32 s92, s92, 8
    s_add_i32 s85, s85, s92
    s_add_i32 s85, s85, s83
    s_ashr_i32 s85, s85, 4
    s_max_i32 s85, s85, -12
    v_mov_b32 v16, s85
    ds_write_b32 v111, v16 offset:9156
    s_add_u32 s94, s94, 1
    s_cmp_le_u32 s94, 31
    s_cbranch_scc1 L_ctl
L_tr:
    ds_read_b32 v16, v111 offset:9164
    buffer_load_dword v18, v82, s[72:75], s38 offen sc1
    s_waitcnt lgkmcnt(0)
    v_cmp_le_u32 vcc, 2, v16
    s_cbranch_vccnz L_trown
    s_waitcnt vmcnt(0)
    v_xor_b32 v18, s39, v18
    v_cmp_eq_u32 vcc, 60, v18
    s_nop 1
    s_bcnt1_i32_b64 s85, vcc
    s_cmp_ge_u32 s85, 4
    s_cbranch_scc1 L_trgo
    s_sleep 2
    s_branch L_tr
L_trown:
    s_or_b32 s92, s39, 60
    v_mov_b32 v17, s92
    s_mov_b64 exec, 1
    buffer_store_dword v17, v111, s[72:75], s36 offen
L_trgo:
    s_mov_b64 exec, -1
    s_mov_b32 s81, s96
    s_mov_b32 s80, 8
L_wo0:
    s_waitcnt vmcnt(23)
    s_mov_b32 m0, s95
    s_add_u32 s95, s95, 1024
    buffer_load_dwordx4 v39, s[64:67], s81 offen nt lds
    s_add_u32 s81, s81, 8192
    s_waitcnt vmcnt(23)
    s_mov_b32 m0, s95
    s_add_u32 s95, s95, 1024
    buffer_load_dwordx4 v39, s[64:67], s81 offen nt lds
    s_add_u32 s81, s81, 8192
    s_waitcnt vmcnt(23)
    s_mov_b32 m0, s95
    s_add_u32 s95, s95, 1024
    buffer_load_dwordx4 v109, s[64:67], s81 offen nt lds
    s_add_u32 s81, s81, 8192
    s_waitcnt vmcnt(23)
    s_mov_b32 m0, s95
    s_add_u32 s95, s95, 1024
    buffer_load_dwordx4 v109, s[64:67], s81 offen nt lds
    s_add_u32 s81, s81, 8192
    s_sub_u32 s80, s80, 1
    s_cmp_lg_u32 s80, 0
    s_cbranch_scc1 L_wo0
    s_mov_b32 s81, s96
    s_mov_b32 s80, 8
L_wo1:
    s_waitcnt vmcnt(23)
    s_mov_b32 m0, s95
    s_add_u32 s95, s95, 1024
    buffer_load_dwordx4 v39, s[68:71], s81 offen nt lds
    s_add_u32 s81, s81, 8192
    s_waitcnt vmcnt(23)
    s_mov_b32 m0, s95
    s_add_u32 s95, s95, 1024
    buffer_load_dwordx4 v39, s[68:71], s81 offen nt lds
    s_add_u32 s81, s81, 8192
    s_waitcnt vmcnt(23)
    s_mov_b32 m0, s95
    s_add_u32 s95, s95, 1024
    buffer_load_dwordx4 v109, s[68:71], s81 offen nt lds
    s_add_u32 s81, s81, 8192
    s_waitcnt vmcnt(23)
    s_mov_b32 m0, s95
    s_add_u32 s95, s95, 1024
    buffer_load_dwordx4 v109, s[68:71], s81 offen nt lds
    s_add_u32 s81, s81, 8192
    s_sub_u32 s80, s80, 1
    s_cmp_lg_u32 s80, 0
    s_cbranch_scc1 L_wo1
    s_waitcnt vmcnt(0)
    s_barrier
    s_mov_b32 s80, 0x100000
L_po:
    buffer_load_dwordx4 v[16:19], v7, s[72:75], s79 offen offset:0 sc1
    buffer_load_dwordx4 v[20:23], v7, s[72:75], s79 offen offset:1024 sc1
    buffer_load_dwordx4 v[24:27], v7, s[72:75], s79 offen offset:2048 sc1
    buffer_load_dwordx4 v[28:31], v7, s[72:75], s79 offen offset:3072 sc1
    buffer_load_dwordx4 v[32:35], v6, s[72:75], s79 offen offset:0 sc1
    buffer_load_dwordx4 v[36:39], v6, s[72:75], s79 offen offset:1024 sc1
    buffer_load_dwordx4 v[40:43], v6, s[72:75], s79 offen offset:2048 sc1
    buffer_load_dwordx4 v[44:47], v6, s[72:75], s79 offen offset:3072 sc1
    v_mov_b32 v80, 0
    s_waitcnt vmcnt(7)
    v_xor_b32 v17, s76, v17
    v_xor_b32 v19, s76, v19
    v_or3_b32 v80, v80, v17, v19
    s_waitcnt vmcnt(6)
    v_xor_b32 v21, s76, v21
    v_xor_b32 v23, s76, v23
    v_or3_b32 v80, v80, v21, v23
    s_waitcnt vmcnt(5)
    v_xor_b32 v25, s76, v25
    v_xor_b32 v27, s76, v27
    v_or3_b32 v80, v80, v25, v27
    s_waitcnt vmcnt(4)
    v_xor_b32 v29, s76, v29
    v_xor_b32 v31, s76, v31
    v_or3_b32 v80, v80, v29, v31
    s_waitcnt vmcnt(3)
    v_xor_b32 v33, s76, v33
    v_xor_b32 v35, s76, v35
    v_or3_b32 v80, v80, v33, v35
    s_waitcnt vmcnt(2)
    v_xor_b32 v37, s76, v37
    v_xor_b32 v39, s76, v39
    v_or3_b32 v80, v80, v37, v39
    s_waitcnt vmcnt(1)
    v_xor_b32 v41, s76, v41
    v_xor_b32 v43, s76, v43
    v_or3_b32 v80, v80, v41, v43
    s_waitcnt vmcnt(0)
    v_xor_b32 v45, s76, v45
    v_xor_b32 v47, s76, v47
    v_or3_b32 v80, v80, v45, v47
    v_cmp_ne_u32 vcc, 0, v80
    s_cbranch_vccz L_po_ok
    s_sleep 2
    s_sub_u32 s80, s80, 1
    s_cmp_lg_u32 s80, 0
    s_cbranch_scc1 L_po
L_po_ok:
    ds_write2_b32 v4, v16, v18 offset0:0 offset1:1
    ds_write2_b32 v4, v20, v22 offset0:68 offset1:69
    ds_write2_b32 v4, v24, v26 offset0:136 offset1:137
    ds_write2_b32 v4, v28, v30 offset0:204 offset1:205
    ds_write2_b32 v5, v32, v34 offset0:0 offset1:1
    ds_write2_b32 v5, v36, v38 offset0:68 offset1:69
    ds_write2_b32 v5, v40, v42 offset0:136 offset1:137
    ds_write2_b32 v5, v44, v46 offset0:204 offset1:205
    s_waitcnt lgkmcnt(0)
L_po_done:
    s_barrier
    s_lshl_b32 s81, s78, 18
    s_lshl_b32 s82, s77, 8
    s_add_u32 s79, s81, s82
    v_lshlrev_b32 v6, 4, v2
    v_lshl_add_u32 v6, v3, 13, v6
    s_bfe_u32 s81, s77, 0x30001
    s_lshl_b32 s81, s81, 12
    s_lshr_b32 s82, s77, 4
    s_lshl_b32 s82, s82, 11
    s_add_u32 s81, s81, s82
    s_lshl_b32 s82, s78, 8
    s_add_u32 s81, s81, s82
    s_and_b32 s82, s77, 1
    s_lshl_b32 s82, s82, 7
    s_add_u32 s96, s81, s82
    v_lshlrev_b32 v4, 3, v2
    s_barrier
    s_or_b32 s92, s39, 110
    v_mov_b32 v17, s92
    s_mov_b64 exec, 1
    buffer_store_dword v17, v111, s[72:75], s36 offen
    s_mov_b64 exec, -1
    s_mov_b32 s80, 64
L_d2:
    buffer_load_dword v18, v82, s[72:75], s38 offen sc1
    s_sub_u32 s80, s80, 1
    s_waitcnt vmcnt(0)
    v_cmp_eq_u32 vcc, s92, v18
    s_cmp_eq_u32 s80, 0
    s_cbranch_scc1 L_d2x
    s_bcnt1_i32_b64 s85, vcc
    s_cmp_lt_u32 s85, 20
    s_cbranch_scc1 L_d2
L_d2x:
    s_mov_b32 s80, 0x100000
L_pp:
    s_add_u32 s92, s79, 0
    buffer_load_dwordx4 v[16:19], v6, s[72:75], s92 offen sc1
    s_add_u32 s92, s79, 32768
    buffer_load_dwordx4 v[20:23], v6, s[72:75], s92 offen sc1
    s_add_u32 s92, s79, 65536
    buffer_load_dwordx4 v[24:27], v6, s[72:75], s92 offen sc1
    s_add_u32 s92, s79, 98304
    buffer_load_dwordx4 v[28:31], v6, s[72:75], s92 offen sc1
    s_add_u32 s92, s79, 131072
    buffer_load_dwordx4 v[32:35], v6, s[72:75], s92 offen sc1
    s_add_u32 s92, s79, 163840
    buffer_load_dwordx4 v[36:39], v6, s[72:75], s92 offen sc1
    s_add_u32 s92, s79, 196608
    buffer_load_dwordx4 v[40:43], v6, s[72:75], s92 offen sc1
    s_add_u32 s92, s79, 229376
    buffer_load_dwordx4 v[44:47], v6, s[72:75], s92 offen sc1
    v_mov_b32 v80, 0
    s_waitcnt vmcnt(7)
    v_xor_b32 v16, s84, v16
    v_xor_b32 v17, s84, v17
    v_xor_b32 v18, s84, v18
    v_xor_b32 v19, s84, v19
    v_or3_b32 v80, v80, v16, v17
    v_or3_b32 v80, v80, v18, v19
    s_waitcnt vmcnt(6)
    v_xor_b32 v20, s84, v20
    v_xor_b32 v21, s84, v21
    v_xor_b32 v22, s84, v22
    v_xor_b32 v23, s84, v23
    v_or3_b32 v80, v80, v20, v21
    v_or3_b32 v80, v80, v22, v23
    s_waitcnt vmcnt(5)
    v_xor_b32 v24, s84, v24
    v_xor_b32 v25, s84, v25
    v_xor_b32 v26, s84, v26
    v_xor_b32 v27, s84, v27
    v_or3_b32 v80, v80, v24, v25
    v_or3_b32 v80, v80, v26, v27
    s_waitcnt vmcnt(4)
    v_xor_b32 v28, s84, v28
    v_xor_b32 v29, s84, v29
    v_xor_b32 v30, s84, v30
    v_xor_b32 v31, s84, v31
    v_or3_b32 v80, v80, v28, v29
    v_or3_b32 v80, v80, v30, v31
    s_waitcnt vmcnt(3)
    v_xor_b32 v32, s84, v32
    v_xor_b32 v33, s84, v33
    v_xor_b32 v34, s84, v34
    v_xor_b32 v35, s84, v35
    v_or3_b32 v80, v80, v32, v33
    v_or3_b32 v80, v80, v34, v35
    s_waitcnt vmcnt(2)
    v_xor_b32 v36, s84, v36
    v_xor_b32 v37, s84, v37
    v_xor_b32 v38, s84, v38
    v_xor_b32 v39, s84, v39
    v_or3_b32 v80, v80, v36, v37
    v_or3_b32 v80, v80, v38, v39
    s_waitcnt vmcnt(1)
    v_xor_b32 v40, s84, v40
    v_xor_b32 v41, s84, v41
    v_xor_b32 v42, s84, v42
    v_xor_b32 v43, s84, v43
    v_or3_b32 v80, v80, v40, v41
    v_or3_b32 v80, v80, v42, v43
    s_waitcnt vmcnt(0)
    v_xor_b32 v44, s84, v44
    v_xor_b32 v45, s84, v45
    v_xor_b32 v46, s84, v46
    v_xor_b32 v47, s84, v47
    v_or3_b32 v80, v80, v44, v45
    v_or3_b32 v80, v80, v46, v47
    v_and_b32 v80, 0xff, v80
    v_cmp_ne_u32 vcc, 0, v80
    s_cbranch_vccz L_pp_ok
    s_sleep 2
    s_sub_u32 s80, s80, 1
    s_cmp_lg_u32 s80, 0
    s_cbranch_scc1 L_pp
L_pp_ok:
    v_add_f32 v16, v16, v20
    v_add_f32 v24, v24, v28
    v_add_f32 v32, v32, v36
    v_add_f32 v40, v40, v44
    v_add_f32 v16, v16, v24
    v_add_f32 v32, v32, v40
    v_add_f32 v16, v16, v32
    v_add_f32 v17, v17, v21
    v_add_f32 v25, v25, v29
    v_add_f32 v33, v33, v37
    v_add_f32 v41, v41, v45
    v_add_f32 v17, v17, v25
    v_add_f32 v33, v33, v41
    v_add_f32 v17, v17, v33
    v_add_f32 v18, v18, v22
    v_add_f32 v26, v26, v30
    v_add_f32 v34, v34, v38
    v_add_f32 v42, v42, v46
    v_add_f32 v18, v18, v26
    v_add_f32 v34, v34, v42
    v_add_f32 v18, v18, v34
    v_add_f32 v19, v19, v23
    v_add_f32 v27, v27, v31
    v_add_f32 v35, v35, v39
    v_add_f32 v43, v43, v47
    v_add_f32 v19, v19, v27
    v_add_f32 v35, v35, v43
    v_add_f32 v19, v19, v35
    v_mov_b32 v20, v16
    v_mov_b32 v21, v17
    v_mov_b32 v22, v18
    v_mov_b32 v23, v19
    s_nop 1
    v_permlane32_swap_b32 v16, v20
    v_permlane32_swap_b32 v17, v21
    v_permlane32_swap_b32 v18, v22
    v_permlane32_swap_b32 v19, v23
    s_nop 1
    v_add_f32 v16, v16, v20
    v_add_f32 v17, v17, v21
    v_add_f32 v18, v18, v22
    v_add_f32 v19, v19, v23
    v_mov_b32 v20, v16
    v_mov_b32 v21, v17
    v_mov_b32 v22, v18
    v_mov_b32 v23, v19
    s_nop 1
    v_permlane16_swap_b32 v16, v20
    v_permlane16_swap_b32 v17, v21
    v_permlane16_swap_b32 v18, v22
    v_permlane16_swap_b32 v19, v23
    s_nop 1
    v_add_f32 v16, v16, v20
    v_add_f32 v17, v17, v21
    v_add_f32 v18, v18, v22
    v_add_f32 v19, v19, v23
    v_cvt_pk_bf16_f32 v16, v16, v17
    v_cvt_pk_bf16_f32 v17, v18, v19
    s_mov_b32 exec_lo, 0xffff
    s_mov_b32 exec_hi, 0
    buffer_store_dwordx2 v[16:17], v4, s[32:35], s96 offen
    s_cmp_lg_u32 s2, 0
    s_cbranch_scc1 L_comm_end
    v_mov_b32 v4, s76
    v_mov_b32 v5, 0
    s_mov_b64 exec, 1
    buffer_store_dword v4, v5, s[72:75], s93 offen
L_comm_end:
L_exit:
    s_endpgm
.section .rodata,"a"
.p2align 6
.amdhsa_kernel concat_heads__mha_block_cached__mha_block_cached__decode_kernel
  .amdhsa_next_free_vgpr 256
  .amdhsa_next_free_sgpr 100
  .amdhsa_accum_offset 256
  .amdhsa_group_segment_fixed_size 0
  .amdhsa_kernarg_size 104
  .amdhsa_user_sgpr_count 2
  .amdhsa_user_sgpr_kernarg_segment_ptr 1
  .amdhsa_system_sgpr_workgroup_id_x 1
  .amdhsa_float_denorm_mode_32 3
.end_amdhsa_kernel
```
